```python
import torch

def _softmax(x, axis=-1):
    return torch.softmax(x, dim=axis)
def _gelu(x):
    return torch.nn.functional.gelu(x, approximate="tanh")
def _silu(x):
    return torch.nn.functional.silu(x)
def _sigmoid(x):
    return torch.sigmoid(x)
def _layernorm(x, axis=-1, eps=1e-5):
    m = x.mean(dim=axis, keepdim=True)
    v = x.var(dim=axis, keepdim=True, unbiased=False)
    return (x - m) / torch.sqrt(v + eps)
def _scatter_add(tgt, idx, src, axis=0):
    return tgt.clone().index_add_(axis, idx, src)
def _segment_sum(src, seg, n):
    out = torch.zeros((n,) + src.shape[1:], dtype=src.dtype)
    return out.index_add_(0, seg, src)
def _pad(x, pw):
    flat = tuple(v for pair in reversed(pw) for v in pair)
    return torch.nn.functional.pad(x, flat)

kernel_name = 'concat_heads__gqa_block_cached__gqa_block_cached__near_ridge'

def setup_inputs():

    _w = (lambda a: (lambda t: t.to(torch.bfloat16) if t.is_floating_point() else t)(torch.as_tensor(a)))
    def _A_setup():
        B, Sq, D = 16, 48, 576
        Hq, Hkv, Sk, Dh = 32, 16, 48, 128
        assert Hq % Hkv == 0, (Hq, Hkv)
        return {
            "x": _w((lambda *s: torch.randn(*s, dtype=torch.bfloat16) * 0.8)(B, Sq, D)),
            "k_cache": _w((lambda *s: torch.randn(*s, dtype=torch.bfloat16) * 0.8)(B, Hkv, Sk, Dh)),
            "v_cache": _w((lambda *s: torch.randn(*s, dtype=torch.bfloat16) * 0.05)(B, Hkv, Sk, Dh)),
            "wq": _w((lambda *s: torch.randn(*s, dtype=torch.bfloat16) * 0.8)(D, Hq * Dh) * (D ** -0.5)),
            "wo": _w((lambda *s: torch.randn(*s, dtype=torch.bfloat16) * 0.05)(Hq * Dh, D) * ((Hq * Dh) ** -0.5)),
        }
    _A_in = _A_setup()

    def _B_setup():
        B, Sq, D = 16, 48, 576
        Hq, Hkv, Sk, Dh = 32, 16, 48, 128
        assert Hq % Hkv == 0, (Hq, Hkv)
        return {
            "x": _w((lambda *s: torch.randn(*s, dtype=torch.bfloat16) * 0.8)(B, Sq, D)),
            "k_cache": _w((lambda *s: torch.randn(*s, dtype=torch.bfloat16) * 0.8)(B, Hkv, Sk, Dh)),
            "v_cache": _w((lambda *s: torch.randn(*s, dtype=torch.bfloat16) * 0.05)(B, Hkv, Sk, Dh)),
            "wq": _w((lambda *s: torch.randn(*s, dtype=torch.bfloat16) * 0.8)(D, Hq * Dh) * (D ** -0.5)),
            "wo": _w((lambda *s: torch.randn(*s, dtype=torch.bfloat16) * 0.05)(Hq * Dh, D) * ((Hq * Dh) ** -0.5)),
        }
    _B_in = _B_setup()

    return {
        "A_x": _A_in["x"],
        "A_k_cache": _A_in["k_cache"],
        "A_v_cache": _A_in["v_cache"],
        "A_wq": _A_in["wq"],
        "A_wo": _A_in["wo"],
        "B_x": _B_in["x"],
        "B_k_cache": _B_in["k_cache"],
        "B_v_cache": _B_in["v_cache"],
        "B_wq": _B_in["wq"],
        "B_wo": _B_in["wo"],
    }

def reference(A_x, A_k_cache, A_v_cache, A_wq, A_wo, B_x, B_k_cache, B_v_cache, B_wq, B_wo):
    def _A_ref(x, k_cache, v_cache, wq, wo):
        B, Sq, D = x.shape
        Hq, Dh = 32, 128
        Hkv = k_cache.shape[1]
        rep = Hq // Hkv
        q = (lambda x, *d: x.permute(*d))((x @ wq).reshape(B, Sq, Hq, Dh), 0, 2, 1, 3)
        k = (lambda x, n, axis: torch.repeat_interleave(x, n, dim=axis))(k_cache, rep, axis=1)
        v = (lambda x, n, axis: torch.repeat_interleave(x, n, dim=axis))(v_cache, rep, axis=1)
        scores = torch.einsum("bhqd,bhkd->bhqk", q, k) * (Dh ** -0.5)
        p = _softmax(scores, axis=-1)
        o = torch.einsum("bhqk,bhkd->bhqd", p, v)
        return (lambda x, *d: x.permute(*d))(o, 0, 2, 1, 3).reshape(B, Sq, Hq * Dh) @ wo

    def _B_ref(x, k_cache, v_cache, wq, wo):
        B, Sq, D = x.shape
        Hq, Dh = 32, 128
        Hkv = k_cache.shape[1]
        rep = Hq // Hkv
        q = (lambda x, *d: x.permute(*d))((x @ wq).reshape(B, Sq, Hq, Dh), 0, 2, 1, 3)
        k = (lambda x, n, axis: torch.repeat_interleave(x, n, dim=axis))(k_cache, rep, axis=1)
        v = (lambda x, n, axis: torch.repeat_interleave(x, n, dim=axis))(v_cache, rep, axis=1)
        scores = torch.einsum("bhqd,bhkd->bhqk", q, k) * (Dh ** -0.5)
        p = _softmax(scores, axis=-1)
        o = torch.einsum("bhqk,bhkd->bhqd", p, v)
        return (lambda x, *d: x.permute(*d))(o, 0, 2, 1, 3).reshape(B, Sq, Hq * Dh) @ wo

    a = _A_ref(A_x, A_k_cache, A_v_cache, A_wq, A_wo)
    b = _B_ref(B_x, B_k_cache, B_v_cache, B_wq, B_wo)
    return torch.concatenate([a, b], axis=-1)
```

```asm
; @launch grid=(256,1,1) block=(512,1,1) lds=163840
.amdgcn_target "amdgcn-amd-amdhsa--gfx950"
.text
.globl concat_heads__gqa_block_cached__gqa_block_cached__near_ridge_kernel
.p2align 8
.type concat_heads__gqa_block_cached__gqa_block_cached__near_ridge_kernel,@function
concat_heads__gqa_block_cached__gqa_block_cached__near_ridge_kernel:
    s_and_b32 s60, s2, 7
    s_lshr_b32 s52, s60, 2
    s_mul_i32 s61, s52, 40
    s_load_dwordx8 s[4:11], s[0:1], s61
    s_load_dwordx2 s[12:13], s[0:1], s61 offset:32
    s_load_dwordx2 s[14:15], s[0:1], 80
    s_load_dwordx4 s[16:19], s[0:1], 88
    s_cmp_ge_u32 s2, 256
    s_cbranch_scc1 L_end
    v_lshrrev_b32 v1, 6, v0
    s_and_b32 s53, s60, 3
    s_lshr_b32 s62, s2, 3
    v_readfirstlane_b32 s58, v1
    s_lshr_b32 s54, s62, 2
    s_and_b32 s55, s62, 3
    s_lshl_b32 s56, s53, 2
    s_add_u32 s56, s56, s55
    v_and_b32 v0, 63, v0
    s_cmp_lt_u32 s58, 4
    s_cbranch_scc1 L_compute
    s_sub_u32 s58, s58, 4
    v_lshrrev_b32 v1, 5, v0
    v_and_b32 v2, 31, v0
    v_lshlrev_b32 v2, 4, v2
    v_lshlrev_b32 v3, 5, v1
    v_xor_b32 v2, v2, v3
    v_lshl_add_u32 v2, v1, 13, v2
    s_lshl_b32 s60, s58, 17
    v_xor_b32 v8, s60, v2
    v_xor_b32 v9, 0x4040, v8
    v_lshrrev_b32 v4, 4, v0
    v_and_b32 v5, 7, v0
    s_mov_b32 s62, 0x8000
    v_xor_b32 v10, s62, v8
    v_xor_b32 v11, s62, v9
    v_xor_b32 v12, 0x10080, v8
    v_xor_b32 v13, 0x10080, v9
    v_xor_b32 v14, s62, v12
    v_xor_b32 v15, s62, v13
    v_xor_b32 v5, v5, v4
    v_lshlrev_b32 v5, 4, v5
    s_and_b32 s61, s58, 1
    s_lshl_b32 s62, s61, 6
    v_xor_b32 v5, s62, v5
    v_lshrrev_b32 v6, 3, v0
    v_mul_u32_u24 v6, 1152, v6
    s_mul_i32 s63, s58, 27648
    v_add3_u32 v16, v5, v6, s63
    v_add_u32 v18, 18432, v16
    v_xor_b32 v5, 64, v5
    s_add_u32 s63, s63, 9216
    v_add3_u32 v17, v5, v6, s63
    s_lshl_b32 s72, s58, 13
    s_mul_i32 s73, s58, 3072
    s_mul_i32 s64, s54, 110592
    s_lshl_b32 s65, s56, 9
    s_add_u32 s59, s54, s55
    s_and_b32 s59, s59, 1
    s_mul_i32 s59, s59, 5
    s_waitcnt lgkmcnt(0)
    s_add_u32 s24, s10, s65
    s_addc_u32 s25, s11, 0
    s_and_b32 s25, s25, 0xffff
    s_sub_u32 s26, 4718592, s65
    s_mov_b32 s27, 0x20000
    s_add_u32 s20, s4, s64
    s_addc_u32 s21, s5, 0
    s_and_b32 s21, s21, 0xffff
    s_sub_u32 s22, 884736, s64
    s_mov_b32 s23, 0x20000
    s_lshl_b32 s60, s59, 19
    s_lshl_b32 s61, s59, 7
    s_add_u32 m0, s73, 32768
    s_nop 0
    buffer_load_dwordx4 v16, s[20:23], s61 offen  lds
    s_addk_i32 m0, 0x400
    s_nop 0
    buffer_load_dwordx4 v17, s[20:23], s61 offen  lds
    s_addk_i32 m0, 0x400
    s_nop 0
    buffer_load_dwordx4 v18, s[20:23], s61 offen  lds
    s_add_u32 m0, s72, 0
    s_nop 0
    buffer_load_dwordx4 v8, s[24:27], s60 offen  lds
    s_addk_i32 m0, 0x400
    s_nop 0
    buffer_load_dwordx4 v9, s[24:27], s60 offen  lds
    s_addk_i32 m0, 0x400
    s_nop 0
    buffer_load_dwordx4 v10, s[24:27], s60 offen  lds
    s_addk_i32 m0, 0x400
    s_nop 0
    buffer_load_dwordx4 v11, s[24:27], s60 offen  lds
    s_addk_i32 m0, 0x400
    s_nop 0
    buffer_load_dwordx4 v12, s[24:27], s60 offen  lds
    s_addk_i32 m0, 0x400
    s_nop 0
    buffer_load_dwordx4 v13, s[24:27], s60 offen  lds
    s_addk_i32 m0, 0x400
    s_nop 0
    buffer_load_dwordx4 v14, s[24:27], s60 offen  lds
    s_addk_i32 m0, 0x400
    s_nop 0
    buffer_load_dwordx4 v15, s[24:27], s60 offen  lds
    s_add_u32 s61, s59, 1
    s_cmp_ge_u32 s61, 9
    s_cselect_b32 s60, 9, 0
    s_sub_u32 s61, s61, s60
    s_lshl_b32 s60, s61, 19
    s_lshl_b32 s61, s61, 7
    s_add_u32 m0, s73, 77824
    s_nop 0
    buffer_load_dwordx4 v16, s[20:23], s61 offen  lds
    s_addk_i32 m0, 0x400
    s_nop 0
    buffer_load_dwordx4 v17, s[20:23], s61 offen  lds
    s_addk_i32 m0, 0x400
    s_nop 0
    buffer_load_dwordx4 v18, s[20:23], s61 offen  lds
    s_add_u32 m0, s72, 45056
    s_nop 0
    buffer_load_dwordx4 v8, s[24:27], s60 offen  lds
    s_addk_i32 m0, 0x400
    s_nop 0
    buffer_load_dwordx4 v9, s[24:27], s60 offen  lds
    s_addk_i32 m0, 0x400
    s_nop 0
    buffer_load_dwordx4 v10, s[24:27], s60 offen  lds
    v_and_b32 v5, 15, v0
    v_xor_b32 v5, v5, v4
    v_lshlrev_b32 v5, 4, v5
    s_and_b32 s61, s58, 1
    s_lshl_b32 s62, s61, 7
    v_xor_b32 v5, s62, v5
    s_mul_i32 s62, s61, 6144
    s_lshr_b32 s63, s58, 1
    s_mul_i32 s63, s63, 196608
    s_add_u32 s62, s62, s63
    v_lshl_add_u32 v6, v4, 8, s62
    v_add_u32 v7, v5, v6
    v_add_u32 v19, 0, v7
    v_xor_b32 v7, 64, v5
    v_add_u32 v7, v7, v6
    v_add_u32 v20, 1024, v7
    v_xor_b32 v7, 128, v5
    v_add_u32 v7, v7, v6
    v_add_u32 v21, 2048, v7
    v_xor_b32 v7, 192, v5
    v_add_u32 v7, v7, v6
    v_add_u32 v22, 3072, v7
    v_add_u32 v7, v5, v6
    v_add_u32 v23, 4096, v7
    v_xor_b32 v7, 64, v5
    v_add_u32 v7, v7, v6
    v_add_u32 v24, 5120, v7
    s_mul_i32 s74, s58, 6144
    s_lshl_b32 s60, s54, 5
    s_add_u32 s61, s60, s56
    s_mul_i32 s61, s61, 12288
    s_lshl_b32 s64, s53, 2
    s_add_u32 s64, s64, s60
    s_mul_i32 s64, s64, 12288
    s_mul_i32 s65, s53, 1179648
    s_add_u32 s28, s6, s61
    s_addc_u32 s29, s7, 0
    s_and_b32 s29, s29, 0xffff
    s_sub_u32 s30, 3145728, s61
    s_mov_b32 s31, 0x20000
    s_add_u32 s32, s8, s64
    s_addc_u32 s33, s9, 0
    s_and_b32 s33, s33, 0xffff
    s_sub_u32 s34, 3145728, s64
    s_mov_b32 s35, 0x20000
    s_add_u32 s36, s12, s65
    s_addc_u32 s37, s13, 0
    s_and_b32 s37, s37, 0xffff
    s_sub_u32 s38, 4718592, s65
    s_mov_b32 s39, 0x20000
    s_mul_i32 s57, s54, 1
    s_add_u32 s57, s55, s57
    s_and_b32 s57, s57, 3
    s_lshl_b32 s68, s52, 3
    s_add_u32 s68, s68, s54
    s_lshl_b32 s68, s68, 4
    s_mul_i32 s60, s52, 1152
    s_add_u32 s44, s14, s60
    s_addc_u32 s45, s15, 0
    s_and_b32 s45, s45, 0xffff
    s_sub_u32 s46, 1769472, s60
    s_mov_b32 s47, 0x20000
    s_mov_b32 s40, s18
    s_and_b32 s41, s19, 0xffff
    s_mov_b32 s42, 14483456
    s_mov_b32 s43, 0x20000
    s_mov_b32 s48, s16
    s_and_b32 s49, s17, 0xffff
    s_mov_b32 s50, 256
    s_mov_b32 s51, 0x20000
    v_and_b32 v5, 15, v0
    v_lshlrev_b32 v6, 1, v4
    v_xor_b32 v5, v5, v6
    v_lshlrev_b32 v5, 4, v5
    v_mul_u32_u24 v6, 1152, v4
    s_mul_i32 s60, s58, 18432
    v_add_u32 v6, s60, v6
    v_add_u32 v25, v5, v6
    v_add_u32 v26, 4608, v25
    v_xor_b32 v5, 128, v5
    v_add_u32 v27, v5, v6
    v_add_u32 v27, 9216, v27
    v_add_u32 v28, 4608, v27
    v_and_b32 v5, 7, v0
    v_and_b32 v6, 1, v4
    v_lshlrev_b32 v6, 1, v6
    v_xor_b32 v5, v5, v6
    v_lshlrev_b32 v5, 4, v5
    v_lshrrev_b32 v6, 3, v0
    v_mul_u32_u24 v6, 1152, v6
    s_lshr_b32 s61, s54, 2
    s_and_b32 s61, s61, 1
    s_mul_i32 s4, s61, 73728
    s_sub_u32 s5, 73728, s4
    s_lshl_b32 s62, s57, 8
    s_add_u32 s4, s4, s62
    s_add_u32 s5, s5, s62
    s_lshl_b32 s61, s61, 1
    s_xor_b32 s61, s61, s58
    s_mul_i32 s60, s61, 36864
    v_add_u32 v6, s60, v6
    v_add_u32 v29, v5, v6
    v_add_u32 v31, 18432, v29
    v_xor_b32 v5, 64, v5
    v_add_u32 v30, v5, v6
    v_add_u32 v30, 9216, v30
    v_add_u32 v32, 18432, v30
    v_lshlrev_b32 v33, 4, v0
    s_lshl_b32 s75, s58, 12
    s_mul_i32 s100, s58, 1536
    s_mul_i32 s101, s58, 3072
    s_cmp_ge_u32 s58, 2
    s_cselect_b32 s60, -1, 1
    s_mul_i32 s60, s60, 36864
    v_add_u32 v140, s60, v25
    v_add_u32 v141, s60, v26
    v_add_u32 v142, s60, v27
    v_add_u32 v143, s60, v28
    v_bfe_u32 v34, v0, 1, 2
    v_and_or_b32 v35, v0, 1, 2
    v_lshlrev_b32 v34, 8, v34
    v_lshl_add_u32 v34, v35, 3, v34
    s_lshl_b32 s65, s53, 2
    s_add_u32 s65, s65, s68
    s_lshl_b32 s65, s65, 8
    s_add_u32 s65, s65, 14155776
Wl_begin:
    s_waitcnt vmcnt(6)
    s_barrier
    s_add_u32 s61, s59, 1
    s_cmp_ge_u32 s61, 9
    s_cselect_b32 s60, 9, 0
    s_sub_u32 s61, s61, s60
    s_lshl_b32 s60, s61, 19
    s_lshl_b32 s61, s61, 7
    s_add_u32 m0, s72, 48128
    s_nop 0
    buffer_load_dwordx4 v11, s[24:27], s60 offen  lds
    s_addk_i32 m0, 0x400
    s_nop 0
    buffer_load_dwordx4 v12, s[24:27], s60 offen  lds
    s_addk_i32 m0, 0x400
    s_nop 0
    buffer_load_dwordx4 v13, s[24:27], s60 offen  lds
    s_addk_i32 m0, 0x400
    s_nop 0
    buffer_load_dwordx4 v14, s[24:27], s60 offen  lds
    s_addk_i32 m0, 0x400
    s_nop 0
    buffer_load_dwordx4 v15, s[24:27], s60 offen  lds
    s_add_u32 s61, s59, 2
    s_cmp_ge_u32 s61, 9
    s_cselect_b32 s60, 9, 0
    s_sub_u32 s61, s61, s60
    s_lshl_b32 s60, s61, 19
    s_lshl_b32 s61, s61, 7
    s_add_u32 m0, s73, 122880
    s_nop 0
    buffer_load_dwordx4 v16, s[20:23], s61 offen  lds
    s_addk_i32 m0, 0x400
    s_nop 0
    buffer_load_dwordx4 v17, s[20:23], s61 offen  lds
    s_addk_i32 m0, 0x400
    s_nop 0
    buffer_load_dwordx4 v18, s[20:23], s61 offen  lds
    s_add_u32 m0, s72, 90112
    s_nop 0
    buffer_load_dwordx4 v8, s[24:27], s60 offen  lds
    s_addk_i32 m0, 0x400
    s_nop 0
    buffer_load_dwordx4 v9, s[24:27], s60 offen  lds
    s_addk_i32 m0, 0x400
    s_nop 0
    buffer_load_dwordx4 v10, s[24:27], s60 offen  lds
    s_addk_i32 m0, 0x400
    s_nop 0
    buffer_load_dwordx4 v11, s[24:27], s60 offen  lds
    s_addk_i32 m0, 0x400
    s_nop 0
    buffer_load_dwordx4 v12, s[24:27], s60 offen  lds
    s_addk_i32 m0, 0x400
    s_nop 0
    buffer_load_dwordx4 v13, s[24:27], s60 offen  lds
    s_addk_i32 m0, 0x400
    s_nop 0
    buffer_load_dwordx4 v14, s[24:27], s60 offen  lds
    s_addk_i32 m0, 0x400
    s_nop 0
    buffer_load_dwordx4 v15, s[24:27], s60 offen  lds
    s_waitcnt vmcnt(11)
    s_barrier
    s_add_u32 s61, s59, 3
    s_cmp_ge_u32 s61, 9
    s_cselect_b32 s60, 9, 0
    s_sub_u32 s61, s61, s60
    s_lshl_b32 s60, s61, 19
    s_lshl_b32 s61, s61, 7
    s_add_u32 m0, s73, 32768
    s_nop 0
    buffer_load_dwordx4 v16, s[20:23], s61 offen  lds
    s_addk_i32 m0, 0x400
    s_nop 0
    buffer_load_dwordx4 v17, s[20:23], s61 offen  lds
    s_addk_i32 m0, 0x400
    s_nop 0
    buffer_load_dwordx4 v18, s[20:23], s61 offen  lds
    s_add_u32 m0, s72, 0
    s_nop 0
    buffer_load_dwordx4 v8, s[24:27], s60 offen  lds
    s_addk_i32 m0, 0x400
    s_nop 0
    buffer_load_dwordx4 v9, s[24:27], s60 offen  lds
    s_addk_i32 m0, 0x400
    s_nop 0
    buffer_load_dwordx4 v10, s[24:27], s60 offen  lds
    s_addk_i32 m0, 0x400
    s_nop 0
    buffer_load_dwordx4 v11, s[24:27], s60 offen  lds
    s_addk_i32 m0, 0x400
    s_nop 0
    buffer_load_dwordx4 v12, s[24:27], s60 offen  lds
    s_addk_i32 m0, 0x400
    s_nop 0
    buffer_load_dwordx4 v13, s[24:27], s60 offen  lds
    s_addk_i32 m0, 0x400
    s_nop 0
    buffer_load_dwordx4 v14, s[24:27], s60 offen  lds
    s_addk_i32 m0, 0x400
    s_nop 0
    buffer_load_dwordx4 v15, s[24:27], s60 offen  lds
    s_waitcnt vmcnt(11)
    s_barrier
    s_add_u32 s61, s59, 4
    s_cmp_ge_u32 s61, 9
    s_cselect_b32 s60, 9, 0
    s_sub_u32 s61, s61, s60
    s_lshl_b32 s60, s61, 19
    s_lshl_b32 s61, s61, 7
    s_add_u32 m0, s73, 77824
    s_nop 0
    buffer_load_dwordx4 v16, s[20:23], s61 offen  lds
    s_addk_i32 m0, 0x400
    s_nop 0
    buffer_load_dwordx4 v17, s[20:23], s61 offen  lds
    s_addk_i32 m0, 0x400
    s_nop 0
    buffer_load_dwordx4 v18, s[20:23], s61 offen  lds
    s_add_u32 m0, s72, 45056
    s_nop 0
    buffer_load_dwordx4 v8, s[24:27], s60 offen  lds
    s_addk_i32 m0, 0x400
    s_nop 0
    buffer_load_dwordx4 v9, s[24:27], s60 offen  lds
    s_addk_i32 m0, 0x400
    s_nop 0
    buffer_load_dwordx4 v10, s[24:27], s60 offen  lds
    s_addk_i32 m0, 0x400
    s_nop 0
    buffer_load_dwordx4 v11, s[24:27], s60 offen  lds
    s_addk_i32 m0, 0x400
    s_nop 0
    buffer_load_dwordx4 v12, s[24:27], s60 offen  lds
    s_addk_i32 m0, 0x400
    s_nop 0
    buffer_load_dwordx4 v13, s[24:27], s60 offen  lds
    s_addk_i32 m0, 0x400
    s_nop 0
    buffer_load_dwordx4 v14, s[24:27], s60 offen  lds
    s_addk_i32 m0, 0x400
    s_nop 0
    buffer_load_dwordx4 v15, s[24:27], s60 offen  lds
    s_waitcnt vmcnt(11)
    s_barrier
    s_add_u32 s61, s59, 5
    s_cmp_ge_u32 s61, 9
    s_cselect_b32 s60, 9, 0
    s_sub_u32 s61, s61, s60
    s_lshl_b32 s60, s61, 19
    s_lshl_b32 s61, s61, 7
    s_add_u32 m0, s73, 122880
    s_nop 0
    buffer_load_dwordx4 v16, s[20:23], s61 offen  lds
    s_addk_i32 m0, 0x400
    s_nop 0
    buffer_load_dwordx4 v17, s[20:23], s61 offen  lds
    s_addk_i32 m0, 0x400
    s_nop 0
    buffer_load_dwordx4 v18, s[20:23], s61 offen  lds
    s_add_u32 m0, s72, 90112
    s_nop 0
    buffer_load_dwordx4 v8, s[24:27], s60 offen  lds
    s_addk_i32 m0, 0x400
    s_nop 0
    buffer_load_dwordx4 v9, s[24:27], s60 offen  lds
    s_addk_i32 m0, 0x400
    s_nop 0
    buffer_load_dwordx4 v10, s[24:27], s60 offen  lds
    s_addk_i32 m0, 0x400
    s_nop 0
    buffer_load_dwordx4 v11, s[24:27], s60 offen  lds
    s_addk_i32 m0, 0x400
    s_nop 0
    buffer_load_dwordx4 v12, s[24:27], s60 offen  lds
    s_addk_i32 m0, 0x400
    s_nop 0
    buffer_load_dwordx4 v13, s[24:27], s60 offen  lds
    s_addk_i32 m0, 0x400
    s_nop 0
    buffer_load_dwordx4 v14, s[24:27], s60 offen  lds
    s_addk_i32 m0, 0x400
    s_nop 0
    buffer_load_dwordx4 v15, s[24:27], s60 offen  lds
    s_waitcnt vmcnt(11)
    s_barrier
    v_mov_b32 v60, 0
    buffer_load_dwordx2 v[62:63], v60, s[48:51], 0 offen sc1
    s_add_u32 s61, s59, 6
    s_cmp_ge_u32 s61, 9
    s_cselect_b32 s60, 9, 0
    s_sub_u32 s61, s61, s60
    s_lshl_b32 s60, s61, 19
    s_lshl_b32 s61, s61, 7
    s_add_u32 m0, s73, 32768
    s_nop 0
    buffer_load_dwordx4 v16, s[20:23], s61 offen  lds
    s_addk_i32 m0, 0x400
    s_nop 0
    buffer_load_dwordx4 v17, s[20:23], s61 offen  lds
    s_addk_i32 m0, 0x400
    s_nop 0
    buffer_load_dwordx4 v18, s[20:23], s61 offen  lds
    s_add_u32 m0, s72, 0
    s_nop 0
    buffer_load_dwordx4 v8, s[24:27], s60 offen  lds
    s_addk_i32 m0, 0x400
    s_nop 0
    buffer_load_dwordx4 v9, s[24:27], s60 offen  lds
    s_addk_i32 m0, 0x400
    s_nop 0
    buffer_load_dwordx4 v10, s[24:27], s60 offen  lds
    s_addk_i32 m0, 0x400
    s_nop 0
    buffer_load_dwordx4 v11, s[24:27], s60 offen  lds
    s_addk_i32 m0, 0x400
    s_nop 0
    buffer_load_dwordx4 v12, s[24:27], s60 offen  lds
    s_addk_i32 m0, 0x400
    s_nop 0
    buffer_load_dwordx4 v13, s[24:27], s60 offen  lds
    s_addk_i32 m0, 0x400
    s_nop 0
    buffer_load_dwordx4 v14, s[24:27], s60 offen  lds
    s_waitcnt vmcnt(11)
    s_barrier
    s_add_u32 s61, s59, 6
    s_cmp_ge_u32 s61, 9
    s_cselect_b32 s60, 9, 0
    s_sub_u32 s61, s61, s60
    s_lshl_b32 s60, s61, 19
    s_lshl_b32 s61, s61, 7
    s_add_u32 m0, s72, 7168
    s_nop 0
    buffer_load_dwordx4 v15, s[24:27], s60 offen  lds
    s_add_u32 m0, s74, 135168
    s_nop 0
    buffer_load_dwordx4 v19, s[28:31], 0 offen  lds
    s_addk_i32 m0, 0x400
    s_nop 0
    buffer_load_dwordx4 v20, s[28:31], 0 offen  lds
    s_addk_i32 m0, 0x400
    s_nop 0
    buffer_load_dwordx4 v21, s[28:31], 0 offen  lds
    s_addk_i32 m0, 0x400
    s_nop 0
    buffer_load_dwordx4 v22, s[28:31], 0 offen  lds
    s_addk_i32 m0, 0x400
    s_nop 0
    buffer_load_dwordx4 v23, s[28:31], 0 offen  lds
    s_addk_i32 m0, 0x400
    s_nop 0
    buffer_load_dwordx4 v24, s[28:31], 0 offen  lds
    s_add_u32 s61, s59, 7
    s_cmp_ge_u32 s61, 9
    s_cselect_b32 s60, 9, 0
    s_sub_u32 s61, s61, s60
    s_lshl_b32 s60, s61, 19
    s_lshl_b32 s61, s61, 7
    s_add_u32 m0, s73, 77824
    s_nop 0
    buffer_load_dwordx4 v16, s[20:23], s61 offen  lds
    s_addk_i32 m0, 0x400
    s_nop 0
    buffer_load_dwordx4 v17, s[20:23], s61 offen  lds
    s_addk_i32 m0, 0x400
    s_nop 0
    buffer_load_dwordx4 v18, s[20:23], s61 offen  lds
    s_add_u32 m0, s72, 45056
    s_nop 0
    buffer_load_dwordx4 v8, s[24:27], s60 offen  lds
    s_addk_i32 m0, 0x400
    s_nop 0
    buffer_load_dwordx4 v9, s[24:27], s60 offen  lds
    s_waitcnt vmcnt(11)
    s_barrier
    s_mov_b32 s69, 500000
L_nonce:
    v_readfirstlane_b32 s66, v62
    v_readfirstlane_b32 s67, v63
    s_sub_u32 s69, s69, 1
    s_cmp_eq_u32 s69, 0
    s_cbranch_scc1 L_nonce_done
    s_cmp_lg_u32 s66, 0
    s_cbranch_scc1 L_nonce_done
    buffer_load_dwordx2 v[62:63], v60, s[48:51], 0 offen sc1
    s_waitcnt vmcnt(0)
    s_branch L_nonce
L_nonce_done:
    s_getreg_b32 s60, hwreg(HW_REG_XCC_ID)
    s_and_b32 s60, s60, 15
    s_add_u32 s60, s60, 1
    s_lshl_b32 s60, s60, 27
    s_mov_b32 s6, s66
    s_add_u32 s7, s67, s60
    s_add_u32 s60, s68, s56
    s_lshl_b32 s60, s60, 8
    s_add_u32 s60, s60, 14155904
    s_cmp_eq_u32 s58, 0
    s_cselect_b32 s60, s60, 0x40000000
    v_mov_b32 v68, s6
    v_mov_b32 v69, s7
    s_mov_b64 exec, 1
    buffer_store_dwordx2 v[68:69], v60, s[40:43], s60 offen sc1
    s_mov_b64 exec, -1
    v_and_b32 v70, 3, v0
    v_lshlrev_b32 v70, 8, v70
    s_add_u32 s61, s59, 7
    s_cmp_ge_u32 s61, 9
    s_cselect_b32 s60, 9, 0
    s_sub_u32 s61, s61, s60
    s_lshl_b32 s60, s61, 19
    s_lshl_b32 s61, s61, 7
    s_add_u32 m0, s72, 47104
    s_nop 0
    buffer_load_dwordx4 v10, s[24:27], s60 offen  lds
    s_addk_i32 m0, 0x400
    s_nop 0
    buffer_load_dwordx4 v11, s[24:27], s60 offen  lds
    s_addk_i32 m0, 0x400
    s_nop 0
    buffer_load_dwordx4 v12, s[24:27], s60 offen  lds
    s_addk_i32 m0, 0x400
    s_nop 0
    buffer_load_dwordx4 v13, s[24:27], s60 offen  lds
    s_addk_i32 m0, 0x400
    s_nop 0
    buffer_load_dwordx4 v14, s[24:27], s60 offen  lds
    s_addk_i32 m0, 0x400
    s_nop 0
    buffer_load_dwordx4 v15, s[24:27], s60 offen  lds
    s_add_u32 s61, s59, 8
    s_cmp_ge_u32 s61, 9
    s_cselect_b32 s60, 9, 0
    s_sub_u32 s61, s61, s60
    s_lshl_b32 s60, s61, 19
    s_lshl_b32 s61, s61, 7
    s_add_u32 m0, s73, 122880
    s_nop 0
    buffer_load_dwordx4 v16, s[20:23], s61 offen  lds
    s_addk_i32 m0, 0x400
    s_nop 0
    buffer_load_dwordx4 v17, s[20:23], s61 offen  lds
    s_addk_i32 m0, 0x400
    s_nop 0
    buffer_load_dwordx4 v18, s[20:23], s61 offen  lds
    s_add_u32 m0, s72, 90112
    s_nop 0
    buffer_load_dwordx4 v8, s[24:27], s60 offen  lds
    s_addk_i32 m0, 0x400
    s_nop 0
    buffer_load_dwordx4 v9, s[24:27], s60 offen  lds
    s_addk_i32 m0, 0x400
    s_nop 0
    buffer_load_dwordx4 v10, s[24:27], s60 offen  lds
    s_addk_i32 m0, 0x400
    s_nop 0
    buffer_load_dwordx4 v11, s[24:27], s60 offen  lds
    s_addk_i32 m0, 0x400
    s_nop 0
    buffer_load_dwordx4 v12, s[24:27], s60 offen  lds
    s_addk_i32 m0, 0x400
    s_nop 0
    buffer_load_dwordx4 v13, s[24:27], s60 offen  lds
    s_addk_i32 m0, 0x400
    s_nop 0
    buffer_load_dwordx4 v14, s[24:27], s60 offen  lds
    s_addk_i32 m0, 0x400
    s_nop 0
    buffer_load_dwordx4 v15, s[24:27], s60 offen  lds
    s_getpc_b64 s[70:71]
L_pcl:
    s_sub_u32 s70, s70, L_pcl-concat_heads__gqa_block_cached__gqa_block_cached__near_ridge_kernel
    s_subb_u32 s71, s71, 0
    s_lshl_b32 s60, s58, 13
    v_lshlrev_b32 v66, 7, v0
    v_add_u32 v66, s60, v66
    v_min_u32 v66, L_end-concat_heads__gqa_block_cached__gqa_block_cached__near_ridge_kernel, v66
    s_cmp_lt_u32 s2, 8
    s_cselect_b64 exec, -1, 1
    global_load_dword v67, v66, s[70:71]
    s_mov_b64 exec, -1
    s_waitcnt vmcnt(12)
    s_barrier
    s_add_u32 s60, s55, 0
    s_and_b32 s60, s60, 3
    s_mul_i32 s60, s60, 12288
    s_add_u32 m0, s74, 0
    s_nop 0
    buffer_load_dwordx4 v19, s[32:35], s60 offen  lds
    s_addk_i32 m0, 0x400
    s_nop 0
    buffer_load_dwordx4 v20, s[32:35], s60 offen  lds
    s_addk_i32 m0, 0x400
    s_nop 0
    buffer_load_dwordx4 v21, s[32:35], s60 offen  lds
    s_addk_i32 m0, 0x400
    s_nop 0
    buffer_load_dwordx4 v22, s[32:35], s60 offen  lds
    s_addk_i32 m0, 0x400
    s_nop 0
    buffer_load_dwordx4 v23, s[32:35], s60 offen  lds
    s_addk_i32 m0, 0x400
    s_nop 0
    buffer_load_dwordx4 v24, s[32:35], s60 offen  lds
    s_mul_i32 s60, s55, 294912
    s_add_u32 s60, s60, 1024
    s_add_u32 m0, s75, 24576
    s_nop 0
    buffer_load_dwordx4 v29, s[36:39], s60 offen  lds
    s_addk_i32 m0, 0x400
    s_nop 0
    buffer_load_dwordx4 v30, s[36:39], s60 offen  lds
    s_addk_i32 m0, 0x400
    s_nop 0
    buffer_load_dwordx4 v31, s[36:39], s60 offen  lds
    s_addk_i32 m0, 0x400
    s_nop 0
    buffer_load_dwordx4 v32, s[36:39], s60 offen  lds
    s_waitcnt vmcnt(11)
    s_barrier
    buffer_load_dwordx2 v[68:69], v70, s[40:43], s65 offen offset:128 sc1
    s_barrier
    s_mul_i32 s60, s55, 294912
    s_add_u32 s60, s60, 148480
    s_add_u32 m0, s75, 45056
    s_nop 0
    buffer_load_dwordx4 v29, s[36:39], s60 offen  lds
    s_addk_i32 m0, 0x400
    s_nop 0
    buffer_load_dwordx4 v30, s[36:39], s60 offen  lds
    s_addk_i32 m0, 0x400
    s_nop 0
    buffer_load_dwordx4 v31, s[36:39], s60 offen  lds
    s_addk_i32 m0, 0x400
    s_nop 0
    buffer_load_dwordx4 v32, s[36:39], s60 offen  lds
    s_add_u32 s60, s55, 0
    s_and_b32 s60, s60, 3
    s_mul_i32 s60, s60, 294912
    s_add_u32 s60, s60, 0
    s_add_u32 s60, s60, s4
    s_add_u32 m0, s75, 61440
    s_nop 0
    buffer_load_dwordx4 v25, s[36:39], s60 offen  lds
    s_addk_i32 m0, 0x400
    s_nop 0
    buffer_load_dwordx4 v26, s[36:39], s60 offen  lds
    s_addk_i32 m0, 0x400
    s_nop 0
    buffer_load_dwordx4 v27, s[36:39], s60 offen  lds
    s_addk_i32 m0, 0x400
    s_nop 0
    buffer_load_dwordx4 v28, s[36:39], s60 offen  lds
    s_add_u32 s60, s55, 0
    s_and_b32 s60, s60, 3
    s_mul_i32 s60, s60, 294912
    s_add_u32 s60, s60, 0
    s_add_u32 s60, s60, s5
    s_add_u32 m0, s75, 77824
    s_nop 0
    buffer_load_dwordx4 v25, s[36:39], s60 offen  lds
    s_addk_i32 m0, 0x400
    s_nop 0
    buffer_load_dwordx4 v26, s[36:39], s60 offen  lds
    s_addk_i32 m0, 0x400
    s_nop 0
    buffer_load_dwordx4 v27, s[36:39], s60 offen  lds
    s_addk_i32 m0, 0x400
    s_nop 0
    buffer_load_dwordx4 v28, s[36:39], s60 offen  lds
    s_add_u32 s60, s55, 0
    s_and_b32 s60, s60, 3
    s_mul_i32 s60, s60, 294912
    s_add_u32 s60, s60, 147456
    s_add_u32 s60, s60, s4
    s_add_u32 m0, s75, 94208
    s_nop 0
    buffer_load_dwordx4 v25, s[36:39], s60 offen  lds
    s_addk_i32 m0, 0x400
    s_nop 0
    buffer_load_dwordx4 v26, s[36:39], s60 offen  lds
    s_addk_i32 m0, 0x400
    s_nop 0
    buffer_load_dwordx4 v27, s[36:39], s60 offen  lds
    s_waitcnt vmcnt(11)
    s_barrier
    s_add_u32 s60, s55, 0
    s_and_b32 s60, s60, 3
    s_mul_i32 s60, s60, 294912
    s_add_u32 s60, s60, 147456
    s_add_u32 s60, s60, s4
    s_add_u32 m0, s75, 97280
    s_nop 0
    buffer_load_dwordx4 v28, s[36:39], s60 offen  lds
    v_cmp_ne_u64 vcc, s[6:7], v[68:69]
    s_nop 1
    s_cmp_eq_u64 vcc, 0
    s_cselect_b32 s13, 1, 0
    s_add_u32 s60, s55, 0
    s_and_b32 s60, s60, 3
    s_lshl_b32 s63, s53, 2
    s_add_u32 s60, s60, s63
    s_add_u32 s60, s60, s68
    s_mul_i32 s60, s60, 18432
    s_and_b32 s61, s58, 1
    s_mul_i32 s61, s61, 9216
    s_add_u32 s60, s60, s61
    s_add_u32 s61, s61, 135168
    v_add_u32 v38, s61, v33
    s_add_u32 s61, s60, 4096
    s_add_u32 s62, s60, 8192
    s_barrier
    s_cmp_ge_u32 s58, 2
    s_cbranch_scc1 L_pubs
    s_waitcnt vmcnt(4)
    s_barrier
    s_add_u32 s60, s55, 0
    s_and_b32 s60, s60, 3
    s_mul_i32 s60, s60, 294912
    s_add_u32 s60, s60, 147456
    s_add_u32 s60, s60, s5
    s_add_u32 m0, s75, 24576
    s_nop 0
    buffer_load_dwordx4 v25, s[36:39], s60 offen  lds
    s_addk_i32 m0, 0x400
    s_nop 0
    buffer_load_dwordx4 v26, s[36:39], s60 offen  lds
    s_addk_i32 m0, 0x400
    s_nop 0
    buffer_load_dwordx4 v27, s[36:39], s60 offen  lds
    s_addk_i32 m0, 0x400
    s_nop 0
    buffer_load_dwordx4 v28, s[36:39], s60 offen  lds
    s_add_u32 m0, s75, 32768
    s_nop 0
    buffer_load_dwordx4 v140, s[36:39], s60 offen  lds
    s_addk_i32 m0, 0x400
    s_nop 0
    buffer_load_dwordx4 v141, s[36:39], s60 offen  lds
    s_addk_i32 m0, 0x400
    s_nop 0
    buffer_load_dwordx4 v142, s[36:39], s60 offen  lds
    s_addk_i32 m0, 0x400
    s_nop 0
    buffer_load_dwordx4 v143, s[36:39], s60 offen  lds
    s_waitcnt vmcnt(0)
    s_barrier
    s_branch L_pubd
L_pubs:
    ds_read_b128 v[96:99], v38 offset:0
    ds_read_b128 v[100:103], v38 offset:1024
    ds_read_b128 v[104:107], v38 offset:2048
    ds_read_b128 v[108:111], v38 offset:3072
    ds_read_b128 v[112:115], v38 offset:4096
    ds_read_b128 v[116:119], v38 offset:5120
    ds_read_b128 v[120:123], v38 offset:6144
    ds_read_b128 v[124:127], v38 offset:7168
    ds_read_b128 v[128:131], v38 offset:8192
    s_cmp_eq_u32 s13, 1
    s_cbranch_scc1 L_pb_l
    s_waitcnt lgkmcnt(8)
    buffer_store_dwordx4 v[96:99], v33, s[40:43], s60 offen offset:0 sc1
    s_waitcnt lgkmcnt(7)
    buffer_store_dwordx4 v[100:103], v33, s[40:43], s60 offen offset:1024 sc1
    s_waitcnt lgkmcnt(6)
    buffer_store_dwordx4 v[104:107], v33, s[40:43], s60 offen offset:2048 sc1
    s_waitcnt lgkmcnt(5)
    buffer_store_dwordx4 v[108:111], v33, s[40:43], s60 offen offset:3072 sc1
    s_waitcnt lgkmcnt(4)
    buffer_store_dwordx4 v[112:115], v33, s[40:43], s61 offen offset:0 sc1
    s_waitcnt lgkmcnt(3)
    buffer_store_dwordx4 v[116:119], v33, s[40:43], s61 offen offset:1024 sc1
    s_waitcnt lgkmcnt(2)
    buffer_store_dwordx4 v[120:123], v33, s[40:43], s61 offen offset:2048 sc1
    s_waitcnt lgkmcnt(1)
    buffer_store_dwordx4 v[124:127], v33, s[40:43], s61 offen offset:3072 sc1
    s_waitcnt lgkmcnt(0)
    buffer_store_dwordx4 v[128:131], v33, s[40:43], s62 offen offset:0 sc1
    s_branch L_pb_d
L_pb_l:
    s_waitcnt lgkmcnt(8)
    buffer_store_dwordx4 v[96:99], v33, s[40:43], s60 offen offset:0
    s_waitcnt lgkmcnt(7)
    buffer_store_dwordx4 v[100:103], v33, s[40:43], s60 offen offset:1024
    s_waitcnt lgkmcnt(6)
    buffer_store_dwordx4 v[104:107], v33, s[40:43], s60 offen offset:2048
    s_waitcnt lgkmcnt(5)
    buffer_store_dwordx4 v[108:111], v33, s[40:43], s60 offen offset:3072
    s_waitcnt lgkmcnt(4)
    buffer_store_dwordx4 v[112:115], v33, s[40:43], s61 offen offset:0
    s_waitcnt lgkmcnt(3)
    buffer_store_dwordx4 v[116:119], v33, s[40:43], s61 offen offset:1024
    s_waitcnt lgkmcnt(2)
    buffer_store_dwordx4 v[120:123], v33, s[40:43], s61 offen offset:2048
    s_waitcnt lgkmcnt(1)
    buffer_store_dwordx4 v[124:127], v33, s[40:43], s61 offen offset:3072
    s_waitcnt lgkmcnt(0)
    buffer_store_dwordx4 v[128:131], v33, s[40:43], s62 offen offset:0
L_pb_d:
    s_waitcnt vmcnt(13)
    s_barrier
    s_add_u32 s60, s55, 1
    s_and_b32 s60, s60, 3
    s_mul_i32 s60, s60, 294912
    s_add_u32 s60, s60, 0
    s_add_u32 s60, s60, s4
    s_add_u32 m0, s75, 45056
    s_nop 0
    buffer_load_dwordx4 v25, s[36:39], s60 offen  lds
    s_addk_i32 m0, 0x400
    s_nop 0
    buffer_load_dwordx4 v26, s[36:39], s60 offen  lds
    s_addk_i32 m0, 0x400
    s_nop 0
    buffer_load_dwordx4 v27, s[36:39], s60 offen  lds
    s_addk_i32 m0, 0x400
    s_nop 0
    buffer_load_dwordx4 v28, s[36:39], s60 offen  lds
    s_add_u32 m0, s75, 36864
    s_nop 0
    buffer_load_dwordx4 v140, s[36:39], s60 offen  lds
    s_addk_i32 m0, 0x400
    s_nop 0
    buffer_load_dwordx4 v141, s[36:39], s60 offen  lds
    s_addk_i32 m0, 0x400
    s_nop 0
    buffer_load_dwordx4 v142, s[36:39], s60 offen  lds
    s_addk_i32 m0, 0x400
    s_nop 0
    buffer_load_dwordx4 v143, s[36:39], s60 offen  lds
    s_waitcnt vmcnt(8)
    s_add_u32 s60, s68, s56
    s_lshl_b32 s60, s60, 8
    s_lshl_b32 s61, s58, 3
    s_add_u32 s60, s60, s61
    s_add_u32 s60, s60, 14155776
    s_mov_b64 exec, 1
    s_cmp_eq_u32 s13, 1
    s_cbranch_scc1 L_fl_l
    buffer_store_dwordx2 v[62:63], v60, s[40:43], s60 offen sc1
    s_branch L_fl_d
L_fl_l:
    buffer_store_dwordx2 v[62:63], v60, s[40:43], s60 offen
L_fl_d:
    s_mov_b64 exec, -1
    s_barrier
L_pubd:
    s_add_u32 s60, s55, 1
    s_and_b32 s60, s60, 3
    s_mul_i32 s60, s60, 294912
    s_add_u32 s60, s60, 0
    s_add_u32 s60, s60, s5
    s_add_u32 m0, s75, 61440
    s_nop 0
    buffer_load_dwordx4 v25, s[36:39], s60 offen  lds
    s_addk_i32 m0, 0x400
    s_nop 0
    buffer_load_dwordx4 v26, s[36:39], s60 offen  lds
    s_addk_i32 m0, 0x400
    s_nop 0
    buffer_load_dwordx4 v27, s[36:39], s60 offen  lds
    s_addk_i32 m0, 0x400
    s_nop 0
    buffer_load_dwordx4 v28, s[36:39], s60 offen  lds
    s_add_u32 s60, s55, 1
    s_and_b32 s60, s60, 3
    s_mul_i32 s60, s60, 12288
    s_add_u32 m0, s74, 110592
    s_nop 0
    buffer_load_dwordx4 v19, s[32:35], s60 offen  lds
    s_addk_i32 m0, 0x400
    s_nop 0
    buffer_load_dwordx4 v20, s[32:35], s60 offen  lds
    s_addk_i32 m0, 0x400
    s_nop 0
    buffer_load_dwordx4 v21, s[32:35], s60 offen  lds
    s_addk_i32 m0, 0x400
    s_nop 0
    buffer_load_dwordx4 v22, s[32:35], s60 offen  lds
    s_addk_i32 m0, 0x400
    s_nop 0
    buffer_load_dwordx4 v23, s[32:35], s60 offen  lds
    s_addk_i32 m0, 0x400
    s_nop 0
    buffer_load_dwordx4 v24, s[32:35], s60 offen  lds
    s_add_u32 s60, s55, 1
    s_and_b32 s60, s60, 3
    s_mul_i32 s60, s60, 294912
    s_add_u32 s60, s60, 147456
    s_add_u32 s60, s60, s4
    s_add_u32 m0, s75, 77824
    s_nop 0
    buffer_load_dwordx4 v25, s[36:39], s60 offen  lds
    s_addk_i32 m0, 0x400
    s_nop 0
    buffer_load_dwordx4 v26, s[36:39], s60 offen  lds
    s_addk_i32 m0, 0x400
    s_nop 0
    buffer_load_dwordx4 v27, s[36:39], s60 offen  lds
    s_addk_i32 m0, 0x400
    s_nop 0
    buffer_load_dwordx4 v28, s[36:39], s60 offen  lds
    buffer_load_dwordx2 v[38:39], v34, s[40:43], s65 offen sc1
    s_waitcnt vmcnt(5)
    s_barrier
    s_add_u32 s60, s55, 1
    s_and_b32 s60, s60, 3
    s_mul_i32 s60, s60, 294912
    s_add_u32 s60, s60, 147456
    s_add_u32 s60, s60, s5
    s_add_u32 m0, s75, 94208
    s_nop 0
    buffer_load_dwordx4 v25, s[36:39], s60 offen  lds
    s_addk_i32 m0, 0x400
    s_nop 0
    buffer_load_dwordx4 v26, s[36:39], s60 offen  lds
    s_addk_i32 m0, 0x400
    s_nop 0
    buffer_load_dwordx4 v27, s[36:39], s60 offen  lds
    s_addk_i32 m0, 0x400
    s_nop 0
    buffer_load_dwordx4 v28, s[36:39], s60 offen  lds
    s_waitcnt vmcnt(4)
    s_mov_b32 s69, 500000
L_poll:
    v_cmp_ne_u64 vcc, s[66:67], v[38:39]
    s_cbranch_vccz L_polld
    s_sub_u32 s69, s69, 1
    s_cmp_eq_u32 s69, 0
    s_cbranch_scc1 L_polld
    buffer_load_dwordx2 v[38:39], v34, s[40:43], s65 offen sc1
    s_waitcnt vmcnt(0)
    s_branch L_poll
L_polld:
    s_add_u32 s60, s55, 1
    s_and_b32 s60, s60, 3
    s_lshl_b32 s63, s53, 2
    s_add_u32 s60, s60, s63
    s_add_u32 s60, s60, s68
    s_mul_i32 s60, s60, 18432
    s_add_u32 s60, s60, s100
    s_add_u32 s60, s60, 0
    s_add_u32 s61, s60, 1024
    s_add_u32 s62, s60, 2048
    s_add_u32 m0, s100, 135168
    s_nop 0
    buffer_load_dwordx4 v33, s[40:43], s60 offen sc1 lds
    s_addk_i32 m0, 0x400
    s_mov_b32 exec_hi, 0
    buffer_load_dwordx4 v33, s[40:43], s61 offen sc1 lds
    s_mov_b32 exec_hi, -1
    s_add_u32 s60, s55, 2
    s_and_b32 s60, s60, 3
    s_mul_i32 s60, s60, 294912
    s_add_u32 s60, s60, 0
    s_add_u32 s60, s60, s4
    s_add_u32 m0, s75, 24576
    s_nop 0
    buffer_load_dwordx4 v25, s[36:39], s60 offen  lds
    s_addk_i32 m0, 0x400
    s_nop 0
    buffer_load_dwordx4 v26, s[36:39], s60 offen  lds
    s_addk_i32 m0, 0x400
    s_nop 0
    buffer_load_dwordx4 v27, s[36:39], s60 offen  lds
    s_addk_i32 m0, 0x400
    s_nop 0
    buffer_load_dwordx4 v28, s[36:39], s60 offen  lds
    s_add_u32 s60, s55, 2
    s_and_b32 s60, s60, 3
    s_mul_i32 s60, s60, 12288
    s_add_u32 m0, s74, 0
    s_nop 0
    buffer_load_dwordx4 v19, s[32:35], s60 offen  lds
    s_addk_i32 m0, 0x400
    s_nop 0
    buffer_load_dwordx4 v20, s[32:35], s60 offen  lds
    s_addk_i32 m0, 0x400
    s_nop 0
    buffer_load_dwordx4 v21, s[32:35], s60 offen  lds
    s_addk_i32 m0, 0x400
    s_nop 0
    buffer_load_dwordx4 v22, s[32:35], s60 offen  lds
    s_addk_i32 m0, 0x400
    s_nop 0
    buffer_load_dwordx4 v23, s[32:35], s60 offen  lds
    s_addk_i32 m0, 0x400
    s_nop 0
    buffer_load_dwordx4 v24, s[32:35], s60 offen  lds
    s_waitcnt vmcnt(10)
    s_barrier
    s_add_u32 s60, s55, 1
    s_and_b32 s60, s60, 3
    s_lshl_b32 s63, s53, 2
    s_add_u32 s60, s60, s63
    s_add_u32 s60, s60, s68
    s_mul_i32 s60, s60, 18432
    s_add_u32 s60, s60, s101
    s_add_u32 s60, s60, 6144
    s_add_u32 s61, s60, 1024
    s_add_u32 s62, s60, 2048
    s_add_u32 m0, s101, 141312
    s_nop 0
    buffer_load_dwordx4 v33, s[40:43], s60 offen sc1 lds
    s_addk_i32 m0, 0x400
    s_nop 0
    buffer_load_dwordx4 v33, s[40:43], s61 offen sc1 lds
    s_addk_i32 m0, 0x400
    s_nop 0
    buffer_load_dwordx4 v33, s[40:43], s62 offen sc1 lds
    s_add_u32 s60, s55, 2
    s_and_b32 s60, s60, 3
    s_mul_i32 s60, s60, 294912
    s_add_u32 s60, s60, 0
    s_add_u32 s60, s60, s5
    s_add_u32 m0, s75, 45056
    s_nop 0
    buffer_load_dwordx4 v25, s[36:39], s60 offen  lds
    s_addk_i32 m0, 0x400
    s_nop 0
    buffer_load_dwordx4 v26, s[36:39], s60 offen  lds
    s_addk_i32 m0, 0x400
    s_nop 0
    buffer_load_dwordx4 v27, s[36:39], s60 offen  lds
    s_addk_i32 m0, 0x400
    s_nop 0
    buffer_load_dwordx4 v28, s[36:39], s60 offen  lds
    s_add_u32 s60, s55, 2
    s_and_b32 s60, s60, 3
    s_mul_i32 s60, s60, 294912
    s_add_u32 s60, s60, 147456
    s_add_u32 s60, s60, s4
    s_add_u32 m0, s75, 61440
    s_nop 0
    buffer_load_dwordx4 v25, s[36:39], s60 offen  lds
    s_addk_i32 m0, 0x400
    s_nop 0
    buffer_load_dwordx4 v26, s[36:39], s60 offen  lds
    s_addk_i32 m0, 0x400
    s_nop 0
    buffer_load_dwordx4 v27, s[36:39], s60 offen  lds
    s_addk_i32 m0, 0x400
    s_nop 0
    buffer_load_dwordx4 v28, s[36:39], s60 offen  lds
    s_waitcnt vmcnt(4)
    s_barrier
    s_add_u32 s60, s55, 2
    s_and_b32 s60, s60, 3
    s_lshl_b32 s63, s53, 2
    s_add_u32 s60, s60, s63
    s_add_u32 s60, s60, s68
    s_mul_i32 s60, s60, 18432
    s_add_u32 s60, s60, s100
    s_add_u32 s60, s60, 0
    s_add_u32 s61, s60, 1024
    s_add_u32 s62, s60, 2048
    s_add_u32 m0, s100, 135168
    s_nop 0
    buffer_load_dwordx4 v33, s[40:43], s60 offen sc1 lds
    s_addk_i32 m0, 0x400
    s_mov_b32 exec_hi, 0
    buffer_load_dwordx4 v33, s[40:43], s61 offen sc1 lds
    s_mov_b32 exec_hi, -1
    s_add_u32 s60, s55, 2
    s_and_b32 s60, s60, 3
    s_mul_i32 s60, s60, 294912
    s_add_u32 s60, s60, 147456
    s_add_u32 s60, s60, s5
    s_add_u32 m0, s75, 77824
    s_nop 0
    buffer_load_dwordx4 v25, s[36:39], s60 offen  lds
    s_addk_i32 m0, 0x400
    s_nop 0
    buffer_load_dwordx4 v26, s[36:39], s60 offen  lds
    s_addk_i32 m0, 0x400
    s_nop 0
    buffer_load_dwordx4 v27, s[36:39], s60 offen  lds
    s_addk_i32 m0, 0x400
    s_nop 0
    buffer_load_dwordx4 v28, s[36:39], s60 offen  lds
    s_add_u32 s60, s55, 3
    s_and_b32 s60, s60, 3
    s_mul_i32 s60, s60, 294912
    s_add_u32 s60, s60, 0
    s_add_u32 s60, s60, s4
    s_add_u32 m0, s75, 94208
    s_nop 0
    buffer_load_dwordx4 v25, s[36:39], s60 offen  lds
    s_addk_i32 m0, 0x400
    s_nop 0
    buffer_load_dwordx4 v26, s[36:39], s60 offen  lds
    s_addk_i32 m0, 0x400
    s_nop 0
    buffer_load_dwordx4 v27, s[36:39], s60 offen  lds
    s_addk_i32 m0, 0x400
    s_nop 0
    buffer_load_dwordx4 v28, s[36:39], s60 offen  lds
    s_add_u32 s60, s55, 3
    s_and_b32 s60, s60, 3
    s_mul_i32 s60, s60, 12288
    s_add_u32 m0, s74, 110592
    s_nop 0
    buffer_load_dwordx4 v19, s[32:35], s60 offen  lds
    s_addk_i32 m0, 0x400
    s_nop 0
    buffer_load_dwordx4 v20, s[32:35], s60 offen  lds
    s_addk_i32 m0, 0x400
    s_nop 0
    buffer_load_dwordx4 v21, s[32:35], s60 offen  lds
    s_addk_i32 m0, 0x400
    s_nop 0
    buffer_load_dwordx4 v22, s[32:35], s60 offen  lds
    s_addk_i32 m0, 0x400
    s_nop 0
    buffer_load_dwordx4 v23, s[32:35], s60 offen  lds
    s_addk_i32 m0, 0x400
    s_nop 0
    buffer_load_dwordx4 v24, s[32:35], s60 offen  lds
    s_waitcnt vmcnt(10)
    s_barrier
    s_add_u32 s60, s55, 2
    s_and_b32 s60, s60, 3
    s_lshl_b32 s63, s53, 2
    s_add_u32 s60, s60, s63
    s_add_u32 s60, s60, s68
    s_mul_i32 s60, s60, 18432
    s_add_u32 s60, s60, s101
    s_add_u32 s60, s60, 6144
    s_add_u32 s61, s60, 1024
    s_add_u32 s62, s60, 2048
    s_add_u32 m0, s101, 141312
    s_nop 0
    buffer_load_dwordx4 v33, s[40:43], s60 offen sc1 lds
    s_addk_i32 m0, 0x400
    s_nop 0
    buffer_load_dwordx4 v33, s[40:43], s61 offen sc1 lds
    s_addk_i32 m0, 0x400
    s_nop 0
    buffer_load_dwordx4 v33, s[40:43], s62 offen sc1 lds
    s_add_u32 s60, s55, 3
    s_and_b32 s60, s60, 3
    s_mul_i32 s60, s60, 294912
    s_add_u32 s60, s60, 0
    s_add_u32 s60, s60, s5
    s_add_u32 m0, s75, 24576
    s_nop 0
    buffer_load_dwordx4 v25, s[36:39], s60 offen  lds
    s_addk_i32 m0, 0x400
    s_nop 0
    buffer_load_dwordx4 v26, s[36:39], s60 offen  lds
    s_addk_i32 m0, 0x400
    s_nop 0
    buffer_load_dwordx4 v27, s[36:39], s60 offen  lds
    s_addk_i32 m0, 0x400
    s_nop 0
    buffer_load_dwordx4 v28, s[36:39], s60 offen  lds
    s_add_u32 s60, s55, 3
    s_and_b32 s60, s60, 3
    s_mul_i32 s60, s60, 294912
    s_add_u32 s60, s60, 147456
    s_add_u32 s60, s60, s4
    s_add_u32 m0, s75, 45056
    s_nop 0
    buffer_load_dwordx4 v25, s[36:39], s60 offen  lds
    s_addk_i32 m0, 0x400
    s_nop 0
    buffer_load_dwordx4 v26, s[36:39], s60 offen  lds
    s_addk_i32 m0, 0x400
    s_nop 0
    buffer_load_dwordx4 v27, s[36:39], s60 offen  lds
    s_addk_i32 m0, 0x400
    s_nop 0
    buffer_load_dwordx4 v28, s[36:39], s60 offen  lds
    s_add_u32 s64, s58, 4
    s_add_u32 s60, s68, s55
    s_lshl_b32 s60, s60, 2
    s_add_u32 s60, s60, s53
    s_mul_i32 s60, s60, 6
    s_add_u32 s60, s60, s64
    s_lshl_b32 s60, s60, 10
    s_add_u32 s60, s60, 4718592
    s_add_u32 s61, s53, 1
    s_and_b32 s61, s61, 3
    s_mul_i32 s61, s61, 98304
    s_add_u32 s6, s60, s61
    s_add_u32 s61, s53, 2
    s_and_b32 s61, s61, 3
    s_mul_i32 s61, s61, 98304
    s_add_u32 s7, s60, s61
    s_add_u32 s61, s53, 3
    s_and_b32 s61, s61, 3
    s_mul_i32 s61, s61, 98304
    s_add_u32 s8, s60, s61
    s_lshl_b32 s9, s64, 10
    s_cmp_ge_u32 s64, 3
    s_cselect_b32 s61, 1, 0
    s_mul_i32 s62, s61, 3
    s_sub_u32 s62, s64, s62
    s_lshr_b32 s63, s53, 1
    s_lshl_b32 s60, s54, 1
    s_add_u32 s63, s63, s60
    s_mul_i32 s63, s63, 48
    s_lshl_b32 s62, s62, 4
    s_add_u32 s63, s63, s62
    s_mul_i32 s63, s63, 2304
    s_lshl_b32 s62, s57, 8
    s_add_u32 s63, s63, s62
    s_and_b32 s62, s53, 1
    s_lshl_b32 s62, s62, 7
    s_add_u32 s63, s63, s62
    s_lshl_b32 s61, s61, 6
    s_add_u32 s10, s63, s61
    s_add_u32 s11, s68, s56
    s_lshl_b32 s11, s11, 9
    s_add_u32 s11, s11, 14221312
    v_and_b32 v156, 15, v0
    v_mul_u32_u24 v156, 2304, v156
    v_bfe_u32 v157, v0, 4, 1
    v_lshl_add_u32 v156, v157, 5, v156
    v_lshrrev_b32 v157, 5, v0
    v_lshl_add_u32 v156, v157, 4, v156
    v_and_b32 v158, 3, v0
    v_min_u32 v158, 2, v158
    v_add3_u32 v158, v158, s53, 1
    v_and_b32 v158, 3, v158
    v_lshlrev_b32 v158, 3, v158
    s_waitcnt vmcnt(4)
    s_barrier
    s_add_u32 s60, s55, 3
    s_and_b32 s60, s60, 3
    s_lshl_b32 s63, s53, 2
    s_add_u32 s60, s60, s63
    s_add_u32 s60, s60, s68
    s_mul_i32 s60, s60, 18432
    s_add_u32 s60, s60, s100
    s_add_u32 s60, s60, 0
    s_add_u32 s61, s60, 1024
    s_add_u32 s62, s60, 2048
    s_add_u32 m0, s100, 135168
    s_nop 0
    buffer_load_dwordx4 v33, s[40:43], s60 offen sc1 lds
    s_addk_i32 m0, 0x400
    s_mov_b32 exec_hi, 0
    buffer_load_dwordx4 v33, s[40:43], s61 offen sc1 lds
    s_mov_b32 exec_hi, -1
    s_add_u32 s60, s55, 3
    s_and_b32 s60, s60, 3
    s_mul_i32 s60, s60, 294912
    s_add_u32 s60, s60, 147456
    s_add_u32 s60, s60, s5
    s_add_u32 m0, s75, 61440
    s_nop 0
    buffer_load_dwordx4 v25, s[36:39], s60 offen  lds
    s_addk_i32 m0, 0x400
    s_nop 0
    buffer_load_dwordx4 v26, s[36:39], s60 offen  lds
    s_addk_i32 m0, 0x400
    s_nop 0
    buffer_load_dwordx4 v27, s[36:39], s60 offen  lds
    s_addk_i32 m0, 0x400
    s_nop 0
    buffer_load_dwordx4 v28, s[36:39], s60 offen  lds
    v_lshrrev_b32 v152, 2, v0
    v_lshlrev_b32 v152, 8, v152
    v_and_b32 v153, 3, v0
    v_lshl_add_u32 v152, v153, 3, v152
    s_lshl_b32 s64, s68, 8
    s_add_u32 s64, s64, 14155968
    s_mul_i32 s60, s56, 48
    s_mul_i32 s61, s58, 12
    s_add_u32 s60, s60, s61
    v_and_b32 v153, 15, v0
    v_min_u32 v144, 11, v153
    v_add_u32 v144, s60, v144
    v_lshrrev_b32 v146, 6, v144
    v_and_b32 v147, 63, v144
    v_mul_u32_u24 v148, 0x56, v146
    v_lshrrev_b32 v148, 8, v148
    v_mul_u32_u24 v149, 3, v148
    v_sub_u32 v149, v146, v149
    v_lshrrev_b32 v150, 1, v148
    v_mul_u32_u24 v150, 48, v150
    v_lshl_add_u32 v150, v149, 4, v150
    v_and_b32 v151, 15, v147
    v_add_u32 v150, v150, v151
    v_mul_u32_u24 v145, 2304, v150
    v_and_b32 v151, 1, v148
    v_lshl_add_u32 v145, v151, 6, v145
    v_lshrrev_b32 v151, 4, v147
    v_lshl_add_u32 v145, v151, 3, v145
    v_lshrrev_b32 v151, 4, v0
    v_and_b32 v146, 1, v151
    v_lshl_add_u32 v145, v146, 2, v145
    v_lshrrev_b32 v146, 1, v151
    v_lshl_add_u32 v145, v146, 5, v145
    v_cmp_gt_u32 vcc, 12, v153
    v_mov_b32 v146, 0x40000000
    s_nop 0
    v_cndmask_b32 v145, v146, v145, vcc
    s_mul_i32 s71, s54, 221184
    s_add_u32 s71, s71, 1024
    v_mul_u32_u24 v151, 49152, v151
    v_lshl_add_u32 v144, v144, 4, v151
    s_mul_i32 s70, s68, 12288
    s_add_u32 s70, s70, 11010048
    s_mov_b32 s69, 500000
L_polle:
    buffer_load_dwordx2 v[38:39], v152, s[40:43], s64 offen sc1
    s_sub_u32 s69, s69, 1
    s_waitcnt vmcnt(0)
    v_cmp_ne_u64 vcc, s[66:67], v[38:39]
    s_cbranch_vccz L_polled
    s_sleep 2
    s_cmp_lg_u32 s69, 0
    s_cbranch_scc1 L_polle
L_polled:
    s_barrier
    s_add_u32 s60, s55, 3
    s_and_b32 s60, s60, 3
    s_lshl_b32 s63, s53, 2
    s_add_u32 s60, s60, s63
    s_add_u32 s60, s60, s68
    s_mul_i32 s60, s60, 18432
    s_add_u32 s60, s60, s101
    s_add_u32 s60, s60, 6144
    s_add_u32 s61, s60, 1024
    s_add_u32 s62, s60, 2048
    s_add_u32 m0, s101, 141312
    s_nop 0
    buffer_load_dwordx4 v33, s[40:43], s60 offen sc1 lds
    s_addk_i32 m0, 0x400
    s_nop 0
    buffer_load_dwordx4 v33, s[40:43], s61 offen sc1 lds
    s_addk_i32 m0, 0x400
    s_nop 0
    buffer_load_dwordx4 v33, s[40:43], s62 offen sc1 lds
    buffer_load_dwordx4 v[72:75], v144, s[40:43], s70 offen sc1
    s_add_u32 s70, s70, 12288
    buffer_load_dwordx4 v[76:79], v144, s[40:43], s70 offen sc1
    s_add_u32 s70, s70, 12288
    buffer_load_dwordx4 v[80:83], v144, s[40:43], s70 offen sc1
    s_add_u32 s70, s70, 12288
    buffer_load_dwordx4 v[84:87], v144, s[40:43], s70 offen sc1
    s_waitcnt vmcnt(4)
    s_barrier
    s_waitcnt vmcnt(0)
    v_lshlrev_b32 v48, 16, v72
    v_and_b32 v49, 0xffff0000, v72
    v_lshlrev_b32 v50, 16, v73
    v_and_b32 v51, 0xffff0000, v73
    v_lshlrev_b32 v52, 16, v74
    v_and_b32 v53, 0xffff0000, v74
    v_lshlrev_b32 v54, 16, v75
    v_and_b32 v55, 0xffff0000, v75
    v_lshlrev_b32 v56, 16, v76
    v_and_b32 v57, 0xffff0000, v76
    v_pk_add_f32 v[48:49], v[48:49], v[56:57]
    v_lshlrev_b32 v58, 16, v77
    v_and_b32 v59, 0xffff0000, v77
    v_pk_add_f32 v[50:51], v[50:51], v[58:59]
    v_lshlrev_b32 v56, 16, v78
    v_and_b32 v57, 0xffff0000, v78
    v_pk_add_f32 v[52:53], v[52:53], v[56:57]
    v_lshlrev_b32 v58, 16, v79
    v_and_b32 v59, 0xffff0000, v79
    v_pk_add_f32 v[54:55], v[54:55], v[58:59]
    v_lshlrev_b32 v56, 16, v80
    v_and_b32 v57, 0xffff0000, v80
    v_pk_add_f32 v[48:49], v[48:49], v[56:57]
    v_lshlrev_b32 v58, 16, v81
    v_and_b32 v59, 0xffff0000, v81
    v_pk_add_f32 v[50:51], v[50:51], v[58:59]
    v_lshlrev_b32 v56, 16, v82
    v_and_b32 v57, 0xffff0000, v82
    v_pk_add_f32 v[52:53], v[52:53], v[56:57]
    v_lshlrev_b32 v58, 16, v83
    v_and_b32 v59, 0xffff0000, v83
    v_pk_add_f32 v[54:55], v[54:55], v[58:59]
    v_lshlrev_b32 v56, 16, v84
    v_and_b32 v57, 0xffff0000, v84
    v_pk_add_f32 v[48:49], v[48:49], v[56:57]
    v_lshlrev_b32 v58, 16, v85
    v_and_b32 v59, 0xffff0000, v85
    v_pk_add_f32 v[50:51], v[50:51], v[58:59]
    v_lshlrev_b32 v56, 16, v86
    v_and_b32 v57, 0xffff0000, v86
    v_pk_add_f32 v[52:53], v[52:53], v[56:57]
    v_lshlrev_b32 v58, 16, v87
    v_and_b32 v59, 0xffff0000, v87
    v_pk_add_f32 v[54:55], v[54:55], v[58:59]
    v_permlane32_swap_b32 v48, v52
    v_permlane32_swap_b32 v49, v53
    v_permlane32_swap_b32 v50, v54
    v_permlane32_swap_b32 v51, v55
    v_pk_add_f32 v[48:49], v[48:49], v[52:53]
    v_pk_add_f32 v[50:51], v[50:51], v[54:55]
    s_nop 1
    v_permlane16_swap_b32 v48, v50
    v_permlane16_swap_b32 v49, v51
    v_pk_add_f32 v[48:49], v[48:49], v[50:51]
    v_cvt_pk_bf16_f32 v56, v48, v49
    buffer_store_dword v56, v145, s[44:47], s71 offen
    s_barrier
    s_cmp_ge_u32 s58, 2
    s_cbranch_scc1 L_fin_l
    v_add_u32 v120, s9, v33
    ds_read_b128 v[108:111], v120 offset:0
    s_waitcnt lgkmcnt(0)
    v_lshlrev_b32 v112, 16, v108
    v_and_b32 v113, 0xffff0000, v108
    v_lshlrev_b32 v114, 16, v109
    v_and_b32 v115, 0xffff0000, v109
    v_lshlrev_b32 v116, 16, v110
    v_and_b32 v117, 0xffff0000, v110
    v_lshlrev_b32 v118, 16, v111
    v_and_b32 v119, 0xffff0000, v111
    s_mov_b32 s69, 500000
L_gl:
    buffer_load_dwordx2 v[124:125], v158, s[40:43], s11 offen sc1
    s_sub_u32 s69, s69, 1
    s_waitcnt vmcnt(0)
    v_cmp_ne_u64 vcc, s[66:67], v[124:125]
    s_cbranch_vccz L_gld
    s_cmp_lg_u32 s69, 0
    s_cbranch_scc1 L_gl
L_gld:
    buffer_load_dwordx4 v[96:99], v33, s[40:43], s6 offen sc1
    buffer_load_dwordx4 v[100:103], v33, s[40:43], s7 offen sc1
    buffer_load_dwordx4 v[104:107], v33, s[40:43], s8 offen sc1
    s_waitcnt vmcnt(2)
    v_lshlrev_b32 v120, 16, v96
    v_and_b32 v121, 0xffff0000, v96
    v_pk_add_f32 v[112:113], v[112:113], v[120:121]
    v_lshlrev_b32 v122, 16, v97
    v_and_b32 v123, 0xffff0000, v97
    v_pk_add_f32 v[114:115], v[114:115], v[122:123]
    v_lshlrev_b32 v120, 16, v98
    v_and_b32 v121, 0xffff0000, v98
    v_pk_add_f32 v[116:117], v[116:117], v[120:121]
    v_lshlrev_b32 v122, 16, v99
    v_and_b32 v123, 0xffff0000, v99
    v_pk_add_f32 v[118:119], v[118:119], v[122:123]
    s_waitcnt vmcnt(1)
    v_lshlrev_b32 v120, 16, v100
    v_and_b32 v121, 0xffff0000, v100
    v_pk_add_f32 v[112:113], v[112:113], v[120:121]
    v_lshlrev_b32 v122, 16, v101
    v_and_b32 v123, 0xffff0000, v101
    v_pk_add_f32 v[114:115], v[114:115], v[122:123]
    v_lshlrev_b32 v120, 16, v102
    v_and_b32 v121, 0xffff0000, v102
    v_pk_add_f32 v[116:117], v[116:117], v[120:121]
    v_lshlrev_b32 v122, 16, v103
    v_and_b32 v123, 0xffff0000, v103
    v_pk_add_f32 v[118:119], v[118:119], v[122:123]
    s_waitcnt vmcnt(0)
    v_lshlrev_b32 v120, 16, v104
    v_and_b32 v121, 0xffff0000, v104
    v_pk_add_f32 v[112:113], v[112:113], v[120:121]
    v_lshlrev_b32 v122, 16, v105
    v_and_b32 v123, 0xffff0000, v105
    v_pk_add_f32 v[114:115], v[114:115], v[122:123]
    v_lshlrev_b32 v120, 16, v106
    v_and_b32 v121, 0xffff0000, v106
    v_pk_add_f32 v[116:117], v[116:117], v[120:121]
    v_lshlrev_b32 v122, 16, v107
    v_and_b32 v123, 0xffff0000, v107
    v_pk_add_f32 v[118:119], v[118:119], v[122:123]
    v_cvt_pk_bf16_f32 v96, v112, v113
    v_cvt_pk_bf16_f32 v97, v114, v115
    v_cvt_pk_bf16_f32 v98, v116, v117
    v_cvt_pk_bf16_f32 v99, v118, v119
    s_nop 0
    v_permlane16_swap_b32 v96, v98
    v_permlane16_swap_b32 v97, v99
    buffer_store_dwordx4 v[96:99], v156, s[44:47], s10 offen
L_fin_l:
    s_endpgm
L_compute:
    s_cmp_ge_u32 s2, 8
    s_cbranch_scc1 L_no_pf
    s_getpc_b64 s[70:71]
L_pc:
    s_sub_u32 s70, s70, L_pc-concat_heads__gqa_block_cached__gqa_block_cached__near_ridge_kernel
    s_subb_u32 s71, s71, 0
    s_lshl_b32 s60, s58, 13
    v_lshlrev_b32 v152, 7, v0
    v_add_u32 v152, s60, v152
    v_min_u32 v152, L_end-concat_heads__gqa_block_cached__gqa_block_cached__near_ridge_kernel, v152
    global_load_dword v153, v152, s[70:71]
L_no_pf:
    s_lshr_b32 s60, s58, 1
    s_and_b32 s61, s58, 1
    v_lshrrev_b32 v48, 4, v0
    v_bfe_u32 v49, v0, 2, 2
    v_and_b32 v50, 3, v0
    v_and_b32 v51, 15, v0
    v_and_b32 v52, 1, v48
    v_lshl_or_b32 v52, v52, 2, v49
    v_lshl_add_u32 v53, v48, 3, v49
    v_lshlrev_b32 v54, 9, v53
    v_lshl_add_u32 v54, v52, 5, v54
    v_lshl_add_u32 v54, v50, 3, v54
    s_lshl_b32 s62, s61, 8
    v_add_u32 v24, s62, v54
    v_xor_b32 v25, 32, v24
    v_xor_b32 v26, 64, v24
    v_xor_b32 v27, 96, v24
    v_xor_b32 v28, 128, v24
    v_xor_b32 v29, 160, v24
    v_xor_b32 v30, 192, v24
    v_xor_b32 v31, 224, v24
    v_lshrrev_b32 v54, 1, v51
    v_xor_b32 v54, v54, v48
    v_lshlrev_b32 v54, 4, v54
    v_lshl_add_u32 v54, v51, 7, v54
    s_mul_i32 s62, s60, 6144
    s_add_u32 s62, s62, 32768
    v_add_u32 v32, s62, v54
    v_xor_b32 v33, 64, v32
    v_lshrrev_b32 v54, 1, v48
    v_xor_b32 v54, v54, v51
    v_lshlrev_b32 v54, 4, v54
    v_lshl_add_u32 v54, v51, 8, v54
    v_and_b32 v55, 1, v48
    v_lshl_add_u32 v54, v55, 3, v54
    s_mul_i32 s62, s60, 12288
    s_add_u32 s63, s62, 135168
    v_add_u32 v37, s63, v54
    v_xor_b32 v38, 32, v37
    v_xor_b32 v39, 64, v37
    v_xor_b32 v40, 96, v37
    v_xor_b32 v41, 128, v37
    v_xor_b32 v42, 160, v37
    v_xor_b32 v43, 192, v37
    v_xor_b32 v44, 224, v37
    s_mul_i32 s63, s60, 3072
    s_add_u32 s63, s63, 135168
    v_lshl_add_u32 v5, v0, 4, s63
    s_mul_i32 s63, s61, 6144
    v_add_u32 v4, s63, v5
    s_lshl_b32 s63, s61, 3
    v_add_u32 v155, s63, v5
    v_xor_b32 v54, v48, v51
    v_lshlrev_b32 v54, 4, v54
    v_lshl_add_u32 v54, v51, 8, v54
    s_lshr_b32 s63, s54, 2
    s_and_b32 s63, s63, 1
    s_lshl_b32 s63, s63, 7
    v_xor_b32 v54, s63, v54
    v_add_u32 v8, s62, v54
    v_xor_b32 v9, 64, v8
    v_xor_b32 v10, 128, v8
    v_xor_b32 v11, 192, v8
    v_lshlrev_b32 v54, 8, v53
    v_lshl_add_u32 v54, v50, 3, v54
    s_lshl_b32 s63, s61, 2
    v_xor_b32 v55, s63, v52
    v_lshl_add_u32 v54, v55, 5, v54
    v_add_u32 v16, 24576, v54
    v_xor_b32 v17, 32, v16
    v_xor_b32 v18, 64, v16
    v_xor_b32 v19, 96, v16
    v_lshlrev_b32 v54, 7, v53
    v_lshl_add_u32 v54, v50, 3, v54
    v_and_b32 v55, 1, v48
    v_lshlrev_b32 v55, 1, v55
    v_lshrrev_b32 v58, 1, v49
    v_or_b32 v55, v55, v58
    s_lshl_b32 s63, s61, 1
    v_xor_b32 v55, s63, v55
    v_lshl_add_u32 v54, v55, 5, v54
    v_add_u32 v56, 24576, v54
    v_xor_b32 v57, 32, v56
    v_add_u32 v20, 53248, v16
    v_add_u32 v12, 110592, v8
    v_add_u32 v21, 53248, v17
    v_add_u32 v13, 110592, v9
    v_add_u32 v22, 53248, v18
    v_add_u32 v14, 110592, v10
    v_add_u32 v23, 53248, v19
    v_add_u32 v15, 110592, v11
    v_lshlrev_b32 v6, 4, v0
    s_mov_b32 s72, 0x3e0293ee
    s_mov_b32 s73, 0x3e0293ee
    v_cmp_eq_u32 vcc, 0, v0
    v_mov_b32 v54, 0x40000000
    s_nop 0
    v_cndmask_b32 v7, v54, 0, vcc
    v_add_u32 v45, 45056, v24
    v_add_u32 v46, 45056, v25
    v_add_u32 v47, 45056, v26
    v_add_u32 v48, 45056, v27
    v_add_u32 v49, 45056, v28
    v_add_u32 v50, 45056, v29
    v_add_u32 v51, 45056, v30
    v_add_u32 v52, 45056, v31
    v_add_u32 v53, 45056, v32
    v_add_u32 v54, 45056, v33
    v_add_u32 v55, 90112, v24
    v_add_u32 v58, 90112, v25
    v_add_u32 v59, 90112, v26
    v_add_u32 v60, 90112, v27
    v_add_u32 v61, 90112, v28
    v_add_u32 v62, 90112, v29
    v_add_u32 v63, 90112, v30
    v_add_u32 v1, 90112, v31
    v_add_u32 v2, 90112, v32
    v_add_u32 v3, 90112, v33
    s_waitcnt lgkmcnt(0)
    s_mul_i32 s57, s54, 1
    s_add_u32 s57, s55, s57
    s_and_b32 s57, s57, 3
    s_lshl_b32 s68, s52, 3
    s_add_u32 s68, s68, s54
    s_lshl_b32 s68, s68, 4
    s_mul_i32 s60, s52, 1152
    s_add_u32 s44, s14, s60
    s_addc_u32 s45, s15, 0
    s_and_b32 s45, s45, 0xffff
    s_sub_u32 s46, 1769472, s60
    s_mov_b32 s47, 0x20000
    s_mov_b32 s40, s18
    s_and_b32 s41, s19, 0xffff
    s_mov_b32 s42, 14483456
    s_mov_b32 s43, 0x20000
    s_mov_b32 s48, s16
    s_and_b32 s49, s17, 0xffff
    s_mov_b32 s50, 256
    s_mov_b32 s51, 0x20000
    s_add_u32 s60, s68, s55
    s_lshl_b32 s60, s60, 2
    s_add_u32 s60, s60, s53
    s_mul_i32 s60, s60, 6
    s_add_u32 s60, s60, s58
    s_lshl_b32 s60, s60, 10
    s_add_u32 s60, s60, 4718592
    s_add_u32 s61, s53, 1
    s_and_b32 s61, s61, 3
    s_mul_i32 s61, s61, 98304
    s_add_u32 s6, s60, s61
    s_add_u32 s61, s53, 2
    s_and_b32 s61, s61, 3
    s_mul_i32 s61, s61, 98304
    s_add_u32 s7, s60, s61
    s_add_u32 s61, s53, 3
    s_and_b32 s61, s61, 3
    s_mul_i32 s61, s61, 98304
    s_add_u32 s8, s60, s61
    s_lshl_b32 s9, s58, 10
    s_cmp_ge_u32 s58, 3
    s_cselect_b32 s61, 1, 0
    s_mul_i32 s62, s61, 3
    s_sub_u32 s62, s58, s62
    s_lshr_b32 s63, s53, 1
    s_lshl_b32 s60, s54, 1
    s_add_u32 s63, s63, s60
    s_mul_i32 s63, s63, 48
    s_lshl_b32 s62, s62, 4
    s_add_u32 s63, s63, s62
    s_mul_i32 s63, s63, 2304
    s_lshl_b32 s62, s57, 8
    s_add_u32 s63, s63, s62
    s_and_b32 s62, s53, 1
    s_lshl_b32 s62, s62, 7
    s_add_u32 s63, s63, s62
    s_lshl_b32 s61, s61, 6
    s_add_u32 s10, s63, s61
    s_add_u32 s11, s68, s56
    s_lshl_b32 s11, s11, 9
    s_add_u32 s11, s11, 14221312
    s_add_u32 s60, s68, s56
    s_lshl_b32 s75, s60, 8
    s_lshl_b32 s61, s58, 3
    s_add_u32 s75, s75, s61
    s_add_u32 s75, s75, 14155968
    s_lshl_b32 s60, s60, 2
    s_add_u32 s60, s60, s58
    s_mul_i32 s74, s60, 3072
    s_add_u32 s74, s74, 11010048
    s_mul_i32 s100, s60, 6144
    s_add_u32 s100, s100, 4718592
    s_cmp_eq_u32 s58, s53
    s_cselect_b32 s100, 0x40000000, s100
    s_add_u32 s101, s100, 3072
    s_lshl_b32 s12, s58, 2
    s_add_u32 s12, s12, s68
    s_add_u32 s12, s12, s55
    s_lshl_b32 s12, s12, 9
    s_lshl_b32 s61, s53, 3
    s_add_u32 s12, s12, s61
    s_add_u32 s12, s12, 14221312
    s_or_b32 s60, s2, s58
    s_cmp_lg_u32 s60, 0
    s_cbranch_scc1 L_no_nonce
    s_memrealtime s[66:67]
    s_waitcnt lgkmcnt(0)
    s_or_b32 s66, s66, 1
    v_mov_b32 v158, s66
    v_mov_b32 v159, s67
    s_mov_b64 exec, 1
    buffer_store_dwordx2 v[158:159], v6, s[48:51], 0 offen sc1
    s_mov_b64 exec, -1
L_no_nonce:
Wc_begin:
    s_barrier
    ds_read_b128 v[128:131], v32 offset:0
    ds_read_b64_tr_b16 v[64:65], v24 offset:0
    ds_read_b64_tr_b16 v[66:67], v24 offset:2048
    ds_read_b128 v[132:135], v32 offset:2048
    ds_read_b128 v[136:139], v32 offset:4096
    ds_read_b64_tr_b16 v[68:69], v25 offset:0
    ds_read_b64_tr_b16 v[70:71], v25 offset:2048
    ds_read_b64_tr_b16 v[72:73], v26 offset:0
    ds_read_b64_tr_b16 v[74:75], v26 offset:2048
    ds_read_b64_tr_b16 v[76:77], v27 offset:0
    ds_read_b64_tr_b16 v[78:79], v27 offset:2048
    ds_read_b64_tr_b16 v[80:81], v28 offset:0
    ds_read_b64_tr_b16 v[82:83], v28 offset:2048
    s_waitcnt lgkmcnt(10)
    v_mfma_f32_16x16x32_bf16 v[160:163], v[64:67], v[128:131], 0
    ds_read_b64_tr_b16 v[84:85], v29 offset:0
    s_waitcnt lgkmcnt(10)
    v_mfma_f32_16x16x32_bf16 v[164:167], v[64:67], v[132:135], 0
    ds_read_b64_tr_b16 v[86:87], v29 offset:2048
    s_waitcnt lgkmcnt(10)
    v_mfma_f32_16x16x32_bf16 v[168:171], v[64:67], v[136:139], 0
    ds_read_b64_tr_b16 v[88:89], v30 offset:0
    ds_read_b64_tr_b16 v[90:91], v30 offset:2048
    s_waitcnt lgkmcnt(10)
    v_mfma_f32_16x16x32_bf16 v[172:175], v[68:71], v[128:131], 0
    ds_read_b64_tr_b16 v[92:93], v31 offset:0
    v_mfma_f32_16x16x32_bf16 v[176:179], v[68:71], v[132:135], 0
    ds_read_b64_tr_b16 v[94:95], v31 offset:2048
    v_mfma_f32_16x16x32_bf16 v[180:183], v[68:71], v[136:139], 0
    ds_read_b128 v[140:143], v33 offset:0
    s_waitcnt lgkmcnt(11)
    v_mfma_f32_16x16x32_bf16 v[184:187], v[72:75], v[128:131], 0
    ds_read_b64_tr_b16 v[96:97], v24 offset:16384
    v_mfma_f32_16x16x32_bf16 v[188:191], v[72:75], v[132:135], 0
    ds_read_b64_tr_b16 v[98:99], v24 offset:18432
    v_mfma_f32_16x16x32_bf16 v[192:195], v[72:75], v[136:139], 0
    ds_read_b128 v[144:147], v33 offset:2048
    s_waitcnt lgkmcnt(10)
    v_mfma_f32_16x16x32_bf16 v[196:199], v[76:79], v[128:131], 0
    ds_read_b128 v[148:151], v33 offset:4096
    v_mfma_f32_16x16x32_bf16 v[200:203], v[76:79], v[132:135], 0
    ds_read_b64_tr_b16 v[100:101], v25 offset:16384
    v_mfma_f32_16x16x32_bf16 v[204:207], v[76:79], v[136:139], 0
    ds_read_b64_tr_b16 v[102:103], v25 offset:18432
    v_mfma_f32_16x16x32_bf16 v[208:211], v[80:83], v[128:131], 0
    ds_read_b64_tr_b16 v[104:105], v26 offset:16384
    v_mfma_f32_16x16x32_bf16 v[212:215], v[80:83], v[132:135], 0
    ds_read_b64_tr_b16 v[106:107], v26 offset:18432
    v_mfma_f32_16x16x32_bf16 v[216:219], v[80:83], v[136:139], 0
    ds_read_b64_tr_b16 v[108:109], v27 offset:16384
    s_waitcnt lgkmcnt(11)
    v_mfma_f32_16x16x32_bf16 v[220:223], v[84:87], v[128:131], 0
    ds_read_b64_tr_b16 v[110:111], v27 offset:18432
    v_mfma_f32_16x16x32_bf16 v[224:227], v[84:87], v[132:135], 0
    ds_read_b64_tr_b16 v[112:113], v28 offset:16384
    v_mfma_f32_16x16x32_bf16 v[228:231], v[84:87], v[136:139], 0
    ds_read_b64_tr_b16 v[114:115], v28 offset:18432
    v_mfma_f32_16x16x32_bf16 v[232:235], v[88:91], v[128:131], 0
    ds_read_b64_tr_b16 v[116:117], v29 offset:16384
    v_mfma_f32_16x16x32_bf16 v[236:239], v[88:91], v[132:135], 0
    ds_read_b64_tr_b16 v[118:119], v29 offset:18432
    v_mfma_f32_16x16x32_bf16 v[240:243], v[88:91], v[136:139], 0
    ds_read_b64_tr_b16 v[120:121], v30 offset:16384
    s_waitcnt lgkmcnt(12)
    v_mfma_f32_16x16x32_bf16 v[244:247], v[92:95], v[128:131], 0
    ds_read_b64_tr_b16 v[122:123], v30 offset:18432
    v_mfma_f32_16x16x32_bf16 v[248:251], v[92:95], v[132:135], 0
    ds_read_b64_tr_b16 v[124:125], v31 offset:16384
    v_mfma_f32_16x16x32_bf16 v[252:255], v[92:95], v[136:139], 0
    ds_read_b64_tr_b16 v[126:127], v31 offset:18432
    v_mfma_f32_16x16x32_bf16 v[160:163], v[96:99], v[140:143], v[160:163]
    v_mfma_f32_16x16x32_bf16 v[164:167], v[96:99], v[144:147], v[164:167]
    s_waitcnt lgkmcnt(0)
    s_barrier
    v_mfma_f32_16x16x32_bf16 v[168:171], v[96:99], v[148:151], v[168:171]
    ds_read_b128 v[128:131], v53 offset:0
    v_mfma_f32_16x16x32_bf16 v[172:175], v[100:103], v[140:143], v[172:175]
    ds_read_b64_tr_b16 v[64:65], v45 offset:0
    v_mfma_f32_16x16x32_bf16 v[176:179], v[100:103], v[144:147], v[176:179]
    ds_read_b64_tr_b16 v[66:67], v45 offset:2048
    v_mfma_f32_16x16x32_bf16 v[180:183], v[100:103], v[148:151], v[180:183]
    ds_read_b128 v[132:135], v53 offset:2048
    v_mfma_f32_16x16x32_bf16 v[184:187], v[104:107], v[140:143], v[184:187]
    ds_read_b128 v[136:139], v53 offset:4096
    v_mfma_f32_16x16x32_bf16 v[188:191], v[104:107], v[144:147], v[188:191]
    ds_read_b64_tr_b16 v[68:69], v46 offset:0
    v_mfma_f32_16x16x32_bf16 v[192:195], v[104:107], v[148:151], v[192:195]
    ds_read_b64_tr_b16 v[70:71], v46 offset:2048
    v_mfma_f32_16x16x32_bf16 v[196:199], v[108:111], v[140:143], v[196:199]
    ds_read_b64_tr_b16 v[72:73], v47 offset:0
    v_mfma_f32_16x16x32_bf16 v[200:203], v[108:111], v[144:147], v[200:203]
    ds_read_b64_tr_b16 v[74:75], v47 offset:2048
    v_mfma_f32_16x16x32_bf16 v[204:207], v[108:111], v[148:151], v[204:207]
    ds_read_b64_tr_b16 v[76:77], v48 offset:0
    v_mfma_f32_16x16x32_bf16 v[208:211], v[112:115], v[140:143], v[208:211]
    ds_read_b64_tr_b16 v[78:79], v48 offset:2048
    v_mfma_f32_16x16x32_bf16 v[212:215], v[112:115], v[144:147], v[212:215]
    ds_read_b64_tr_b16 v[80:81], v49 offset:0
    v_mfma_f32_16x16x32_bf16 v[216:219], v[112:115], v[148:151], v[216:219]
    ds_read_b64_tr_b16 v[82:83], v49 offset:2048
    v_mfma_f32_16x16x32_bf16 v[220:223], v[116:119], v[140:143], v[220:223]
    ds_read_b64_tr_b16 v[84:85], v50 offset:0
    v_mfma_f32_16x16x32_bf16 v[224:227], v[116:119], v[144:147], v[224:227]
    ds_read_b64_tr_b16 v[86:87], v50 offset:2048
    v_mfma_f32_16x16x32_bf16 v[228:231], v[116:119], v[148:151], v[228:231]
    ds_read_b64_tr_b16 v[88:89], v51 offset:0
    v_mfma_f32_16x16x32_bf16 v[232:235], v[120:123], v[140:143], v[232:235]
    ds_read_b64_tr_b16 v[90:91], v51 offset:2048
    v_mfma_f32_16x16x32_bf16 v[236:239], v[120:123], v[144:147], v[236:239]
    ds_read_b64_tr_b16 v[92:93], v52 offset:0
    v_mfma_f32_16x16x32_bf16 v[240:243], v[120:123], v[148:151], v[240:243]
    ds_read_b64_tr_b16 v[94:95], v52 offset:2048
    v_mfma_f32_16x16x32_bf16 v[244:247], v[124:127], v[140:143], v[244:247]
    ds_read_b128 v[140:143], v54 offset:0
    v_mfma_f32_16x16x32_bf16 v[248:251], v[124:127], v[144:147], v[248:251]
    ds_read_b64_tr_b16 v[96:97], v45 offset:16384
    v_mfma_f32_16x16x32_bf16 v[252:255], v[124:127], v[148:151], v[252:255]
    ds_read_b64_tr_b16 v[98:99], v45 offset:18432
    s_waitcnt lgkmcnt(12)
    v_mfma_f32_16x16x32_bf16 v[160:163], v[64:67], v[128:131], v[160:163]
    ds_read_b128 v[144:147], v54 offset:2048
    v_mfma_f32_16x16x32_bf16 v[164:167], v[64:67], v[132:135], v[164:167]
    ds_read_b128 v[148:151], v54 offset:4096
    v_mfma_f32_16x16x32_bf16 v[168:171], v[64:67], v[136:139], v[168:171]
    ds_read_b64_tr_b16 v[100:101], v46 offset:16384
    v_mfma_f32_16x16x32_bf16 v[172:175], v[68:71], v[128:131], v[172:175]
    ds_read_b64_tr_b16 v[102:103], v46 offset:18432
    v_mfma_f32_16x16x32_bf16 v[176:179], v[68:71], v[132:135], v[176:179]
    ds_read_b64_tr_b16 v[104:105], v47 offset:16384
    v_mfma_f32_16x16x32_bf16 v[180:183], v[68:71], v[136:139], v[180:183]
    ds_read_b64_tr_b16 v[106:107], v47 offset:18432
    v_mfma_f32_16x16x32_bf16 v[184:187], v[72:75], v[128:131], v[184:187]
    ds_read_b64_tr_b16 v[108:109], v48 offset:16384
    v_mfma_f32_16x16x32_bf16 v[188:191], v[72:75], v[132:135], v[188:191]
    ds_read_b64_tr_b16 v[110:111], v48 offset:18432
    v_mfma_f32_16x16x32_bf16 v[192:195], v[72:75], v[136:139], v[192:195]
    ds_read_b64_tr_b16 v[112:113], v49 offset:16384
    s_waitcnt lgkmcnt(12)
    v_mfma_f32_16x16x32_bf16 v[196:199], v[76:79], v[128:131], v[196:199]
    ds_read_b64_tr_b16 v[114:115], v49 offset:18432
    v_mfma_f32_16x16x32_bf16 v[200:203], v[76:79], v[132:135], v[200:203]
    ds_read_b64_tr_b16 v[116:117], v50 offset:16384
    v_mfma_f32_16x16x32_bf16 v[204:207], v[76:79], v[136:139], v[204:207]
    ds_read_b64_tr_b16 v[118:119], v50 offset:18432
    v_mfma_f32_16x16x32_bf16 v[208:211], v[80:83], v[128:131], v[208:211]
    ds_read_b64_tr_b16 v[120:121], v51 offset:16384
    v_mfma_f32_16x16x32_bf16 v[212:215], v[80:83], v[132:135], v[212:215]
    ds_read_b64_tr_b16 v[122:123], v51 offset:18432
    v_mfma_f32_16x16x32_bf16 v[216:219], v[80:83], v[136:139], v[216:219]
    ds_read_b64_tr_b16 v[124:125], v52 offset:16384
    v_mfma_f32_16x16x32_bf16 v[220:223], v[84:87], v[128:131], v[220:223]
    ds_read_b64_tr_b16 v[126:127], v52 offset:18432
    v_mfma_f32_16x16x32_bf16 v[224:227], v[84:87], v[132:135], v[224:227]
    v_mfma_f32_16x16x32_bf16 v[228:231], v[84:87], v[136:139], v[228:231]
    v_mfma_f32_16x16x32_bf16 v[232:235], v[88:91], v[128:131], v[232:235]
    v_mfma_f32_16x16x32_bf16 v[236:239], v[88:91], v[132:135], v[236:239]
    v_mfma_f32_16x16x32_bf16 v[240:243], v[88:91], v[136:139], v[240:243]
    v_mfma_f32_16x16x32_bf16 v[244:247], v[92:95], v[128:131], v[244:247]
    v_mfma_f32_16x16x32_bf16 v[248:251], v[92:95], v[132:135], v[248:251]
    v_mfma_f32_16x16x32_bf16 v[252:255], v[92:95], v[136:139], v[252:255]
    s_waitcnt lgkmcnt(8)
    v_mfma_f32_16x16x32_bf16 v[160:163], v[96:99], v[140:143], v[160:163]
    v_mfma_f32_16x16x32_bf16 v[164:167], v[96:99], v[144:147], v[164:167]
    s_waitcnt lgkmcnt(0)
    s_barrier
    v_mfma_f32_16x16x32_bf16 v[168:171], v[96:99], v[148:151], v[168:171]
    ds_read_b128 v[128:131], v2 offset:0
    v_mfma_f32_16x16x32_bf16 v[172:175], v[100:103], v[140:143], v[172:175]
    ds_read_b64_tr_b16 v[64:65], v55 offset:0
    v_mfma_f32_16x16x32_bf16 v[176:179], v[100:103], v[144:147], v[176:179]
    ds_read_b64_tr_b16 v[66:67], v55 offset:2048
    v_mfma_f32_16x16x32_bf16 v[180:183], v[100:103], v[148:151], v[180:183]
    ds_read_b128 v[132:135], v2 offset:2048
    v_mfma_f32_16x16x32_bf16 v[184:187], v[104:107], v[140:143], v[184:187]
    ds_read_b128 v[136:139], v2 offset:4096
    v_mfma_f32_16x16x32_bf16 v[188:191], v[104:107], v[144:147], v[188:191]
    ds_read_b64_tr_b16 v[68:69], v58 offset:0
    v_mfma_f32_16x16x32_bf16 v[192:195], v[104:107], v[148:151], v[192:195]
    ds_read_b64_tr_b16 v[70:71], v58 offset:2048
    v_mfma_f32_16x16x32_bf16 v[196:199], v[108:111], v[140:143], v[196:199]
    ds_read_b64_tr_b16 v[72:73], v59 offset:0
    v_mfma_f32_16x16x32_bf16 v[200:203], v[108:111], v[144:147], v[200:203]
    ds_read_b64_tr_b16 v[74:75], v59 offset:2048
    v_mfma_f32_16x16x32_bf16 v[204:207], v[108:111], v[148:151], v[204:207]
    ds_read_b64_tr_b16 v[76:77], v60 offset:0
    v_mfma_f32_16x16x32_bf16 v[208:211], v[112:115], v[140:143], v[208:211]
    ds_read_b64_tr_b16 v[78:79], v60 offset:2048
    v_mfma_f32_16x16x32_bf16 v[212:215], v[112:115], v[144:147], v[212:215]
    ds_read_b64_tr_b16 v[80:81], v61 offset:0
    v_mfma_f32_16x16x32_bf16 v[216:219], v[112:115], v[148:151], v[216:219]
    ds_read_b64_tr_b16 v[82:83], v61 offset:2048
    v_mfma_f32_16x16x32_bf16 v[220:223], v[116:119], v[140:143], v[220:223]
    ds_read_b64_tr_b16 v[84:85], v62 offset:0
    v_mfma_f32_16x16x32_bf16 v[224:227], v[116:119], v[144:147], v[224:227]
    ds_read_b64_tr_b16 v[86:87], v62 offset:2048
    v_mfma_f32_16x16x32_bf16 v[228:231], v[116:119], v[148:151], v[228:231]
    ds_read_b64_tr_b16 v[88:89], v63 offset:0
    v_mfma_f32_16x16x32_bf16 v[232:235], v[120:123], v[140:143], v[232:235]
    ds_read_b64_tr_b16 v[90:91], v63 offset:2048
    v_mfma_f32_16x16x32_bf16 v[236:239], v[120:123], v[144:147], v[236:239]
    ds_read_b64_tr_b16 v[92:93], v1 offset:0
    v_mfma_f32_16x16x32_bf16 v[240:243], v[120:123], v[148:151], v[240:243]
    ds_read_b64_tr_b16 v[94:95], v1 offset:2048
    v_mfma_f32_16x16x32_bf16 v[244:247], v[124:127], v[140:143], v[244:247]
    ds_read_b128 v[140:143], v3 offset:0
    v_mfma_f32_16x16x32_bf16 v[248:251], v[124:127], v[144:147], v[248:251]
    ds_read_b64_tr_b16 v[96:97], v55 offset:16384
    v_mfma_f32_16x16x32_bf16 v[252:255], v[124:127], v[148:151], v[252:255]
    ds_read_b64_tr_b16 v[98:99], v55 offset:18432
    s_waitcnt lgkmcnt(12)
    v_mfma_f32_16x16x32_bf16 v[160:163], v[64:67], v[128:131], v[160:163]
    ds_read_b128 v[144:147], v3 offset:2048
    v_mfma_f32_16x16x32_bf16 v[164:167], v[64:67], v[132:135], v[164:167]
    ds_read_b128 v[148:151], v3 offset:4096
    v_mfma_f32_16x16x32_bf16 v[168:171], v[64:67], v[136:139], v[168:171]
    ds_read_b64_tr_b16 v[100:101], v58 offset:16384
    v_mfma_f32_16x16x32_bf16 v[172:175], v[68:71], v[128:131], v[172:175]
    ds_read_b64_tr_b16 v[102:103], v58 offset:18432
    v_mfma_f32_16x16x32_bf16 v[176:179], v[68:71], v[132:135], v[176:179]
    ds_read_b64_tr_b16 v[104:105], v59 offset:16384
    v_mfma_f32_16x16x32_bf16 v[180:183], v[68:71], v[136:139], v[180:183]
    ds_read_b64_tr_b16 v[106:107], v59 offset:18432
    v_mfma_f32_16x16x32_bf16 v[184:187], v[72:75], v[128:131], v[184:187]
    ds_read_b64_tr_b16 v[108:109], v60 offset:16384
    v_mfma_f32_16x16x32_bf16 v[188:191], v[72:75], v[132:135], v[188:191]
    ds_read_b64_tr_b16 v[110:111], v60 offset:18432
    v_mfma_f32_16x16x32_bf16 v[192:195], v[72:75], v[136:139], v[192:195]
    ds_read_b64_tr_b16 v[112:113], v61 offset:16384
    s_waitcnt lgkmcnt(12)
    v_mfma_f32_16x16x32_bf16 v[196:199], v[76:79], v[128:131], v[196:199]
    ds_read_b64_tr_b16 v[114:115], v61 offset:18432
    v_mfma_f32_16x16x32_bf16 v[200:203], v[76:79], v[132:135], v[200:203]
    ds_read_b64_tr_b16 v[116:117], v62 offset:16384
    v_mfma_f32_16x16x32_bf16 v[204:207], v[76:79], v[136:139], v[204:207]
    ds_read_b64_tr_b16 v[118:119], v62 offset:18432
    v_mfma_f32_16x16x32_bf16 v[208:211], v[80:83], v[128:131], v[208:211]
    ds_read_b64_tr_b16 v[120:121], v63 offset:16384
    v_mfma_f32_16x16x32_bf16 v[212:215], v[80:83], v[132:135], v[212:215]
    ds_read_b64_tr_b16 v[122:123], v63 offset:18432
    v_mfma_f32_16x16x32_bf16 v[216:219], v[80:83], v[136:139], v[216:219]
    ds_read_b64_tr_b16 v[124:125], v1 offset:16384
    v_mfma_f32_16x16x32_bf16 v[220:223], v[84:87], v[128:131], v[220:223]
    ds_read_b64_tr_b16 v[126:127], v1 offset:18432
    v_mfma_f32_16x16x32_bf16 v[224:227], v[84:87], v[132:135], v[224:227]
    v_mfma_f32_16x16x32_bf16 v[228:231], v[84:87], v[136:139], v[228:231]
    v_mfma_f32_16x16x32_bf16 v[232:235], v[88:91], v[128:131], v[232:235]
    v_mfma_f32_16x16x32_bf16 v[236:239], v[88:91], v[132:135], v[236:239]
    v_mfma_f32_16x16x32_bf16 v[240:243], v[88:91], v[136:139], v[240:243]
    v_mfma_f32_16x16x32_bf16 v[244:247], v[92:95], v[128:131], v[244:247]
    v_mfma_f32_16x16x32_bf16 v[248:251], v[92:95], v[132:135], v[248:251]
    v_mfma_f32_16x16x32_bf16 v[252:255], v[92:95], v[136:139], v[252:255]
    s_waitcnt lgkmcnt(8)
    v_mfma_f32_16x16x32_bf16 v[160:163], v[96:99], v[140:143], v[160:163]
    v_mfma_f32_16x16x32_bf16 v[164:167], v[96:99], v[144:147], v[164:167]
    s_waitcnt lgkmcnt(0)
    s_barrier
    v_mfma_f32_16x16x32_bf16 v[168:171], v[96:99], v[148:151], v[168:171]
    ds_read_b128 v[128:131], v32 offset:0
    v_mfma_f32_16x16x32_bf16 v[172:175], v[100:103], v[140:143], v[172:175]
    ds_read_b64_tr_b16 v[64:65], v24 offset:0
    v_mfma_f32_16x16x32_bf16 v[176:179], v[100:103], v[144:147], v[176:179]
    ds_read_b64_tr_b16 v[66:67], v24 offset:2048
    v_mfma_f32_16x16x32_bf16 v[180:183], v[100:103], v[148:151], v[180:183]
    ds_read_b128 v[132:135], v32 offset:2048
    v_mfma_f32_16x16x32_bf16 v[184:187], v[104:107], v[140:143], v[184:187]
    ds_read_b128 v[136:139], v32 offset:4096
    v_mfma_f32_16x16x32_bf16 v[188:191], v[104:107], v[144:147], v[188:191]
    ds_read_b64_tr_b16 v[68:69], v25 offset:0
    v_mfma_f32_16x16x32_bf16 v[192:195], v[104:107], v[148:151], v[192:195]
    ds_read_b64_tr_b16 v[70:71], v25 offset:2048
    v_mfma_f32_16x16x32_bf16 v[196:199], v[108:111], v[140:143], v[196:199]
    ds_read_b64_tr_b16 v[72:73], v26 offset:0
    v_mfma_f32_16x16x32_bf16 v[200:203], v[108:111], v[144:147], v[200:203]
    ds_read_b64_tr_b16 v[74:75], v26 offset:2048
    v_mfma_f32_16x16x32_bf16 v[204:207], v[108:111], v[148:151], v[204:207]
    ds_read_b64_tr_b16 v[76:77], v27 offset:0
    v_mfma_f32_16x16x32_bf16 v[208:211], v[112:115], v[140:143], v[208:211]
    ds_read_b64_tr_b16 v[78:79], v27 offset:2048
    v_mfma_f32_16x16x32_bf16 v[212:215], v[112:115], v[144:147], v[212:215]
    ds_read_b64_tr_b16 v[80:81], v28 offset:0
    v_mfma_f32_16x16x32_bf16 v[216:219], v[112:115], v[148:151], v[216:219]
    ds_read_b64_tr_b16 v[82:83], v28 offset:2048
    v_mfma_f32_16x16x32_bf16 v[220:223], v[116:119], v[140:143], v[220:223]
    ds_read_b64_tr_b16 v[84:85], v29 offset:0
    v_mfma_f32_16x16x32_bf16 v[224:227], v[116:119], v[144:147], v[224:227]
    ds_read_b64_tr_b16 v[86:87], v29 offset:2048
    v_mfma_f32_16x16x32_bf16 v[228:231], v[116:119], v[148:151], v[228:231]
    ds_read_b64_tr_b16 v[88:89], v30 offset:0
    v_mfma_f32_16x16x32_bf16 v[232:235], v[120:123], v[140:143], v[232:235]
    ds_read_b64_tr_b16 v[90:91], v30 offset:2048
    v_mfma_f32_16x16x32_bf16 v[236:239], v[120:123], v[144:147], v[236:239]
    ds_read_b64_tr_b16 v[92:93], v31 offset:0
    v_mfma_f32_16x16x32_bf16 v[240:243], v[120:123], v[148:151], v[240:243]
    ds_read_b64_tr_b16 v[94:95], v31 offset:2048
    v_mfma_f32_16x16x32_bf16 v[244:247], v[124:127], v[140:143], v[244:247]
    ds_read_b128 v[140:143], v33 offset:0
    v_mfma_f32_16x16x32_bf16 v[248:251], v[124:127], v[144:147], v[248:251]
    ds_read_b64_tr_b16 v[96:97], v24 offset:16384
    v_mfma_f32_16x16x32_bf16 v[252:255], v[124:127], v[148:151], v[252:255]
    ds_read_b64_tr_b16 v[98:99], v24 offset:18432
    s_waitcnt lgkmcnt(12)
    v_mfma_f32_16x16x32_bf16 v[160:163], v[64:67], v[128:131], v[160:163]
    ds_read_b128 v[144:147], v33 offset:2048
    v_mfma_f32_16x16x32_bf16 v[164:167], v[64:67], v[132:135], v[164:167]
    ds_read_b128 v[148:151], v33 offset:4096
    v_mfma_f32_16x16x32_bf16 v[168:171], v[64:67], v[136:139], v[168:171]
    ds_read_b64_tr_b16 v[100:101], v25 offset:16384
    v_mfma_f32_16x16x32_bf16 v[172:175], v[68:71], v[128:131], v[172:175]
    ds_read_b64_tr_b16 v[102:103], v25 offset:18432
    v_mfma_f32_16x16x32_bf16 v[176:179], v[68:71], v[132:135], v[176:179]
    ds_read_b64_tr_b16 v[104:105], v26 offset:16384
    v_mfma_f32_16x16x32_bf16 v[180:183], v[68:71], v[136:139], v[180:183]
    ds_read_b64_tr_b16 v[106:107], v26 offset:18432
    v_mfma_f32_16x16x32_bf16 v[184:187], v[72:75], v[128:131], v[184:187]
    ds_read_b64_tr_b16 v[108:109], v27 offset:16384
    v_mfma_f32_16x16x32_bf16 v[188:191], v[72:75], v[132:135], v[188:191]
    ds_read_b64_tr_b16 v[110:111], v27 offset:18432
    v_mfma_f32_16x16x32_bf16 v[192:195], v[72:75], v[136:139], v[192:195]
    ds_read_b64_tr_b16 v[112:113], v28 offset:16384
    s_waitcnt lgkmcnt(12)
    v_mfma_f32_16x16x32_bf16 v[196:199], v[76:79], v[128:131], v[196:199]
    ds_read_b64_tr_b16 v[114:115], v28 offset:18432
    v_mfma_f32_16x16x32_bf16 v[200:203], v[76:79], v[132:135], v[200:203]
    ds_read_b64_tr_b16 v[116:117], v29 offset:16384
    v_mfma_f32_16x16x32_bf16 v[204:207], v[76:79], v[136:139], v[204:207]
    ds_read_b64_tr_b16 v[118:119], v29 offset:18432
    v_mfma_f32_16x16x32_bf16 v[208:211], v[80:83], v[128:131], v[208:211]
    ds_read_b64_tr_b16 v[120:121], v30 offset:16384
    v_mfma_f32_16x16x32_bf16 v[212:215], v[80:83], v[132:135], v[212:215]
    ds_read_b64_tr_b16 v[122:123], v30 offset:18432
    v_mfma_f32_16x16x32_bf16 v[216:219], v[80:83], v[136:139], v[216:219]
    ds_read_b64_tr_b16 v[124:125], v31 offset:16384
    v_mfma_f32_16x16x32_bf16 v[220:223], v[84:87], v[128:131], v[220:223]
    ds_read_b64_tr_b16 v[126:127], v31 offset:18432
    v_mfma_f32_16x16x32_bf16 v[224:227], v[84:87], v[132:135], v[224:227]
    v_mfma_f32_16x16x32_bf16 v[228:231], v[84:87], v[136:139], v[228:231]
    v_mfma_f32_16x16x32_bf16 v[232:235], v[88:91], v[128:131], v[232:235]
    v_mfma_f32_16x16x32_bf16 v[236:239], v[88:91], v[132:135], v[236:239]
    v_mfma_f32_16x16x32_bf16 v[240:243], v[88:91], v[136:139], v[240:243]
    v_mfma_f32_16x16x32_bf16 v[244:247], v[92:95], v[128:131], v[244:247]
    v_mfma_f32_16x16x32_bf16 v[248:251], v[92:95], v[132:135], v[248:251]
    v_mfma_f32_16x16x32_bf16 v[252:255], v[92:95], v[136:139], v[252:255]
    s_waitcnt lgkmcnt(8)
    v_mfma_f32_16x16x32_bf16 v[160:163], v[96:99], v[140:143], v[160:163]
    v_mfma_f32_16x16x32_bf16 v[164:167], v[96:99], v[144:147], v[164:167]
    s_waitcnt lgkmcnt(0)
    s_barrier
    v_mfma_f32_16x16x32_bf16 v[168:171], v[96:99], v[148:151], v[168:171]
    ds_read_b128 v[128:131], v53 offset:0
    v_mfma_f32_16x16x32_bf16 v[172:175], v[100:103], v[140:143], v[172:175]
    ds_read_b64_tr_b16 v[64:65], v45 offset:0
    v_mfma_f32_16x16x32_bf16 v[176:179], v[100:103], v[144:147], v[176:179]
    ds_read_b64_tr_b16 v[66:67], v45 offset:2048
    v_mfma_f32_16x16x32_bf16 v[180:183], v[100:103], v[148:151], v[180:183]
    ds_read_b128 v[132:135], v53 offset:2048
    v_mfma_f32_16x16x32_bf16 v[184:187], v[104:107], v[140:143], v[184:187]
    ds_read_b128 v[136:139], v53 offset:4096
    v_mfma_f32_16x16x32_bf16 v[188:191], v[104:107], v[144:147], v[188:191]
    ds_read_b64_tr_b16 v[68:69], v46 offset:0
    v_mfma_f32_16x16x32_bf16 v[192:195], v[104:107], v[148:151], v[192:195]
    ds_read_b64_tr_b16 v[70:71], v46 offset:2048
    v_mfma_f32_16x16x32_bf16 v[196:199], v[108:111], v[140:143], v[196:199]
    ds_read_b64_tr_b16 v[72:73], v47 offset:0
    v_mfma_f32_16x16x32_bf16 v[200:203], v[108:111], v[144:147], v[200:203]
    ds_read_b64_tr_b16 v[74:75], v47 offset:2048
    v_mfma_f32_16x16x32_bf16 v[204:207], v[108:111], v[148:151], v[204:207]
    ds_read_b64_tr_b16 v[76:77], v48 offset:0
    v_mfma_f32_16x16x32_bf16 v[208:211], v[112:115], v[140:143], v[208:211]
    ds_read_b64_tr_b16 v[78:79], v48 offset:2048
    v_mfma_f32_16x16x32_bf16 v[212:215], v[112:115], v[144:147], v[212:215]
    ds_read_b64_tr_b16 v[80:81], v49 offset:0
    v_mfma_f32_16x16x32_bf16 v[216:219], v[112:115], v[148:151], v[216:219]
    ds_read_b64_tr_b16 v[82:83], v49 offset:2048
    v_mfma_f32_16x16x32_bf16 v[220:223], v[116:119], v[140:143], v[220:223]
    ds_read_b64_tr_b16 v[84:85], v50 offset:0
    v_mfma_f32_16x16x32_bf16 v[224:227], v[116:119], v[144:147], v[224:227]
    ds_read_b64_tr_b16 v[86:87], v50 offset:2048
    v_mfma_f32_16x16x32_bf16 v[228:231], v[116:119], v[148:151], v[228:231]
    ds_read_b64_tr_b16 v[88:89], v51 offset:0
    v_mfma_f32_16x16x32_bf16 v[232:235], v[120:123], v[140:143], v[232:235]
    ds_read_b64_tr_b16 v[90:91], v51 offset:2048
    v_mfma_f32_16x16x32_bf16 v[236:239], v[120:123], v[144:147], v[236:239]
    ds_read_b64_tr_b16 v[92:93], v52 offset:0
    v_mfma_f32_16x16x32_bf16 v[240:243], v[120:123], v[148:151], v[240:243]
    ds_read_b64_tr_b16 v[94:95], v52 offset:2048
    v_mfma_f32_16x16x32_bf16 v[244:247], v[124:127], v[140:143], v[244:247]
    ds_read_b128 v[140:143], v54 offset:0
    v_mfma_f32_16x16x32_bf16 v[248:251], v[124:127], v[144:147], v[248:251]
    ds_read_b64_tr_b16 v[96:97], v45 offset:16384
    v_mfma_f32_16x16x32_bf16 v[252:255], v[124:127], v[148:151], v[252:255]
    ds_read_b64_tr_b16 v[98:99], v45 offset:18432
    s_waitcnt lgkmcnt(12)
    v_mfma_f32_16x16x32_bf16 v[160:163], v[64:67], v[128:131], v[160:163]
    ds_read_b128 v[144:147], v54 offset:2048
    v_mfma_f32_16x16x32_bf16 v[164:167], v[64:67], v[132:135], v[164:167]
    ds_read_b128 v[148:151], v54 offset:4096
    v_mfma_f32_16x16x32_bf16 v[168:171], v[64:67], v[136:139], v[168:171]
    ds_read_b64_tr_b16 v[100:101], v46 offset:16384
    v_mfma_f32_16x16x32_bf16 v[172:175], v[68:71], v[128:131], v[172:175]
    ds_read_b64_tr_b16 v[102:103], v46 offset:18432
    v_mfma_f32_16x16x32_bf16 v[176:179], v[68:71], v[132:135], v[176:179]
    ds_read_b64_tr_b16 v[104:105], v47 offset:16384
    v_mfma_f32_16x16x32_bf16 v[180:183], v[68:71], v[136:139], v[180:183]
    ds_read_b64_tr_b16 v[106:107], v47 offset:18432
    v_mfma_f32_16x16x32_bf16 v[184:187], v[72:75], v[128:131], v[184:187]
    ds_read_b64_tr_b16 v[108:109], v48 offset:16384
    v_mfma_f32_16x16x32_bf16 v[188:191], v[72:75], v[132:135], v[188:191]
    ds_read_b64_tr_b16 v[110:111], v48 offset:18432
    v_mfma_f32_16x16x32_bf16 v[192:195], v[72:75], v[136:139], v[192:195]
    ds_read_b64_tr_b16 v[112:113], v49 offset:16384
    s_waitcnt lgkmcnt(12)
    v_mfma_f32_16x16x32_bf16 v[196:199], v[76:79], v[128:131], v[196:199]
    ds_read_b64_tr_b16 v[114:115], v49 offset:18432
    v_mfma_f32_16x16x32_bf16 v[200:203], v[76:79], v[132:135], v[200:203]
    ds_read_b64_tr_b16 v[116:117], v50 offset:16384
    v_mfma_f32_16x16x32_bf16 v[204:207], v[76:79], v[136:139], v[204:207]
    ds_read_b64_tr_b16 v[118:119], v50 offset:18432
    v_mfma_f32_16x16x32_bf16 v[208:211], v[80:83], v[128:131], v[208:211]
    ds_read_b64_tr_b16 v[120:121], v51 offset:16384
    v_mfma_f32_16x16x32_bf16 v[212:215], v[80:83], v[132:135], v[212:215]
    ds_read_b64_tr_b16 v[122:123], v51 offset:18432
    v_mfma_f32_16x16x32_bf16 v[216:219], v[80:83], v[136:139], v[216:219]
    ds_read_b64_tr_b16 v[124:125], v52 offset:16384
    v_mfma_f32_16x16x32_bf16 v[220:223], v[84:87], v[128:131], v[220:223]
    ds_read_b64_tr_b16 v[126:127], v52 offset:18432
    v_mfma_f32_16x16x32_bf16 v[224:227], v[84:87], v[132:135], v[224:227]
    v_mfma_f32_16x16x32_bf16 v[228:231], v[84:87], v[136:139], v[228:231]
    v_mfma_f32_16x16x32_bf16 v[232:235], v[88:91], v[128:131], v[232:235]
    v_mfma_f32_16x16x32_bf16 v[236:239], v[88:91], v[132:135], v[236:239]
    v_mfma_f32_16x16x32_bf16 v[240:243], v[88:91], v[136:139], v[240:243]
    v_mfma_f32_16x16x32_bf16 v[244:247], v[92:95], v[128:131], v[244:247]
    v_mfma_f32_16x16x32_bf16 v[248:251], v[92:95], v[132:135], v[248:251]
    v_mfma_f32_16x16x32_bf16 v[252:255], v[92:95], v[136:139], v[252:255]
    s_waitcnt lgkmcnt(8)
    v_mfma_f32_16x16x32_bf16 v[160:163], v[96:99], v[140:143], v[160:163]
    v_mfma_f32_16x16x32_bf16 v[164:167], v[96:99], v[144:147], v[164:167]
    s_waitcnt lgkmcnt(0)
    s_barrier
    v_mfma_f32_16x16x32_bf16 v[168:171], v[96:99], v[148:151], v[168:171]
    ds_read_b128 v[128:131], v2 offset:0
    v_mfma_f32_16x16x32_bf16 v[172:175], v[100:103], v[140:143], v[172:175]
    ds_read_b64_tr_b16 v[64:65], v55 offset:0
    v_mfma_f32_16x16x32_bf16 v[176:179], v[100:103], v[144:147], v[176:179]
    ds_read_b64_tr_b16 v[66:67], v55 offset:2048
    v_mfma_f32_16x16x32_bf16 v[180:183], v[100:103], v[148:151], v[180:183]
    ds_read_b128 v[132:135], v2 offset:2048
    v_mfma_f32_16x16x32_bf16 v[184:187], v[104:107], v[140:143], v[184:187]
    ds_read_b128 v[136:139], v2 offset:4096
    v_mfma_f32_16x16x32_bf16 v[188:191], v[104:107], v[144:147], v[188:191]
    ds_read_b64_tr_b16 v[68:69], v58 offset:0
    v_mfma_f32_16x16x32_bf16 v[192:195], v[104:107], v[148:151], v[192:195]
    ds_read_b64_tr_b16 v[70:71], v58 offset:2048
    v_mfma_f32_16x16x32_bf16 v[196:199], v[108:111], v[140:143], v[196:199]
    ds_read_b64_tr_b16 v[72:73], v59 offset:0
    v_mfma_f32_16x16x32_bf16 v[200:203], v[108:111], v[144:147], v[200:203]
    ds_read_b64_tr_b16 v[74:75], v59 offset:2048
    v_mfma_f32_16x16x32_bf16 v[204:207], v[108:111], v[148:151], v[204:207]
    ds_read_b64_tr_b16 v[76:77], v60 offset:0
    v_mfma_f32_16x16x32_bf16 v[208:211], v[112:115], v[140:143], v[208:211]
    ds_read_b64_tr_b16 v[78:79], v60 offset:2048
    v_mfma_f32_16x16x32_bf16 v[212:215], v[112:115], v[144:147], v[212:215]
    ds_read_b64_tr_b16 v[80:81], v61 offset:0
    v_mfma_f32_16x16x32_bf16 v[216:219], v[112:115], v[148:151], v[216:219]
    ds_read_b64_tr_b16 v[82:83], v61 offset:2048
    v_mfma_f32_16x16x32_bf16 v[220:223], v[116:119], v[140:143], v[220:223]
    ds_read_b64_tr_b16 v[84:85], v62 offset:0
    v_mfma_f32_16x16x32_bf16 v[224:227], v[116:119], v[144:147], v[224:227]
    ds_read_b64_tr_b16 v[86:87], v62 offset:2048
    v_mfma_f32_16x16x32_bf16 v[228:231], v[116:119], v[148:151], v[228:231]
    ds_read_b64_tr_b16 v[88:89], v63 offset:0
    v_mfma_f32_16x16x32_bf16 v[232:235], v[120:123], v[140:143], v[232:235]
    ds_read_b64_tr_b16 v[90:91], v63 offset:2048
    v_mfma_f32_16x16x32_bf16 v[236:239], v[120:123], v[144:147], v[236:239]
    ds_read_b64_tr_b16 v[92:93], v1 offset:0
    v_mfma_f32_16x16x32_bf16 v[240:243], v[120:123], v[148:151], v[240:243]
    ds_read_b64_tr_b16 v[94:95], v1 offset:2048
    v_mfma_f32_16x16x32_bf16 v[244:247], v[124:127], v[140:143], v[244:247]
    ds_read_b128 v[140:143], v3 offset:0
    v_mfma_f32_16x16x32_bf16 v[248:251], v[124:127], v[144:147], v[248:251]
    ds_read_b64_tr_b16 v[96:97], v55 offset:16384
    v_mfma_f32_16x16x32_bf16 v[252:255], v[124:127], v[148:151], v[252:255]
    ds_read_b64_tr_b16 v[98:99], v55 offset:18432
    s_waitcnt lgkmcnt(12)
    v_mfma_f32_16x16x32_bf16 v[160:163], v[64:67], v[128:131], v[160:163]
    ds_read_b128 v[144:147], v3 offset:2048
    v_mfma_f32_16x16x32_bf16 v[164:167], v[64:67], v[132:135], v[164:167]
    ds_read_b128 v[148:151], v3 offset:4096
    v_mfma_f32_16x16x32_bf16 v[168:171], v[64:67], v[136:139], v[168:171]
    ds_read_b64_tr_b16 v[100:101], v58 offset:16384
    v_mfma_f32_16x16x32_bf16 v[172:175], v[68:71], v[128:131], v[172:175]
    ds_read_b64_tr_b16 v[102:103], v58 offset:18432
    v_mfma_f32_16x16x32_bf16 v[176:179], v[68:71], v[132:135], v[176:179]
    ds_read_b64_tr_b16 v[104:105], v59 offset:16384
    v_mfma_f32_16x16x32_bf16 v[180:183], v[68:71], v[136:139], v[180:183]
    ds_read_b64_tr_b16 v[106:107], v59 offset:18432
    v_mfma_f32_16x16x32_bf16 v[184:187], v[72:75], v[128:131], v[184:187]
    ds_read_b64_tr_b16 v[108:109], v60 offset:16384
    v_mfma_f32_16x16x32_bf16 v[188:191], v[72:75], v[132:135], v[188:191]
    ds_read_b64_tr_b16 v[110:111], v60 offset:18432
    v_mfma_f32_16x16x32_bf16 v[192:195], v[72:75], v[136:139], v[192:195]
    ds_read_b64_tr_b16 v[112:113], v61 offset:16384
    s_waitcnt lgkmcnt(12)
    v_mfma_f32_16x16x32_bf16 v[196:199], v[76:79], v[128:131], v[196:199]
    ds_read_b64_tr_b16 v[114:115], v61 offset:18432
    v_mfma_f32_16x16x32_bf16 v[200:203], v[76:79], v[132:135], v[200:203]
    ds_read_b64_tr_b16 v[116:117], v62 offset:16384
    v_mfma_f32_16x16x32_bf16 v[204:207], v[76:79], v[136:139], v[204:207]
    ds_read_b64_tr_b16 v[118:119], v62 offset:18432
    v_mfma_f32_16x16x32_bf16 v[208:211], v[80:83], v[128:131], v[208:211]
    ds_read_b64_tr_b16 v[120:121], v63 offset:16384
    v_mfma_f32_16x16x32_bf16 v[212:215], v[80:83], v[132:135], v[212:215]
    ds_read_b64_tr_b16 v[122:123], v63 offset:18432
    v_mfma_f32_16x16x32_bf16 v[216:219], v[80:83], v[136:139], v[216:219]
    ds_read_b64_tr_b16 v[124:125], v1 offset:16384
    v_mfma_f32_16x16x32_bf16 v[220:223], v[84:87], v[128:131], v[220:223]
    ds_read_b64_tr_b16 v[126:127], v1 offset:18432
    v_mfma_f32_16x16x32_bf16 v[224:227], v[84:87], v[132:135], v[224:227]
    v_mfma_f32_16x16x32_bf16 v[228:231], v[84:87], v[136:139], v[228:231]
    v_mfma_f32_16x16x32_bf16 v[232:235], v[88:91], v[128:131], v[232:235]
    v_mfma_f32_16x16x32_bf16 v[236:239], v[88:91], v[132:135], v[236:239]
    v_mfma_f32_16x16x32_bf16 v[240:243], v[88:91], v[136:139], v[240:243]
    v_mfma_f32_16x16x32_bf16 v[244:247], v[92:95], v[128:131], v[244:247]
    v_mfma_f32_16x16x32_bf16 v[248:251], v[92:95], v[132:135], v[248:251]
    v_mfma_f32_16x16x32_bf16 v[252:255], v[92:95], v[136:139], v[252:255]
    s_waitcnt lgkmcnt(8)
    v_mfma_f32_16x16x32_bf16 v[160:163], v[96:99], v[140:143], v[160:163]
    v_mfma_f32_16x16x32_bf16 v[164:167], v[96:99], v[144:147], v[164:167]
    s_waitcnt lgkmcnt(0)
    s_barrier
    v_mfma_f32_16x16x32_bf16 v[168:171], v[96:99], v[148:151], v[168:171]
    ds_read_b128 v[128:131], v32 offset:0
    v_mfma_f32_16x16x32_bf16 v[172:175], v[100:103], v[140:143], v[172:175]
    ds_read_b64_tr_b16 v[64:65], v24 offset:0
    v_mfma_f32_16x16x32_bf16 v[176:179], v[100:103], v[144:147], v[176:179]
    ds_read_b64_tr_b16 v[66:67], v24 offset:2048
    v_mfma_f32_16x16x32_bf16 v[180:183], v[100:103], v[148:151], v[180:183]
    ds_read_b128 v[132:135], v32 offset:2048
    v_mfma_f32_16x16x32_bf16 v[184:187], v[104:107], v[140:143], v[184:187]
    ds_read_b128 v[136:139], v32 offset:4096
    v_mfma_f32_16x16x32_bf16 v[188:191], v[104:107], v[144:147], v[188:191]
    ds_read_b64_tr_b16 v[68:69], v25 offset:0
    v_mfma_f32_16x16x32_bf16 v[192:195], v[104:107], v[148:151], v[192:195]
    ds_read_b64_tr_b16 v[70:71], v25 offset:2048
    v_mfma_f32_16x16x32_bf16 v[196:199], v[108:111], v[140:143], v[196:199]
    ds_read_b64_tr_b16 v[72:73], v26 offset:0
    v_mfma_f32_16x16x32_bf16 v[200:203], v[108:111], v[144:147], v[200:203]
    ds_read_b64_tr_b16 v[74:75], v26 offset:2048
    v_mfma_f32_16x16x32_bf16 v[204:207], v[108:111], v[148:151], v[204:207]
    ds_read_b64_tr_b16 v[76:77], v27 offset:0
    v_mfma_f32_16x16x32_bf16 v[208:211], v[112:115], v[140:143], v[208:211]
    ds_read_b64_tr_b16 v[78:79], v27 offset:2048
    v_mfma_f32_16x16x32_bf16 v[212:215], v[112:115], v[144:147], v[212:215]
    ds_read_b64_tr_b16 v[80:81], v28 offset:0
    v_mfma_f32_16x16x32_bf16 v[216:219], v[112:115], v[148:151], v[216:219]
    ds_read_b64_tr_b16 v[82:83], v28 offset:2048
    v_mfma_f32_16x16x32_bf16 v[220:223], v[116:119], v[140:143], v[220:223]
    ds_read_b64_tr_b16 v[84:85], v29 offset:0
    v_mfma_f32_16x16x32_bf16 v[224:227], v[116:119], v[144:147], v[224:227]
    ds_read_b64_tr_b16 v[86:87], v29 offset:2048
    v_mfma_f32_16x16x32_bf16 v[228:231], v[116:119], v[148:151], v[228:231]
    ds_read_b64_tr_b16 v[88:89], v30 offset:0
    v_mfma_f32_16x16x32_bf16 v[232:235], v[120:123], v[140:143], v[232:235]
    ds_read_b64_tr_b16 v[90:91], v30 offset:2048
    v_mfma_f32_16x16x32_bf16 v[236:239], v[120:123], v[144:147], v[236:239]
    ds_read_b64_tr_b16 v[92:93], v31 offset:0
    v_mfma_f32_16x16x32_bf16 v[240:243], v[120:123], v[148:151], v[240:243]
    ds_read_b64_tr_b16 v[94:95], v31 offset:2048
    v_mfma_f32_16x16x32_bf16 v[244:247], v[124:127], v[140:143], v[244:247]
    ds_read_b128 v[140:143], v33 offset:0
    v_mfma_f32_16x16x32_bf16 v[248:251], v[124:127], v[144:147], v[248:251]
    ds_read_b64_tr_b16 v[96:97], v24 offset:16384
    v_mfma_f32_16x16x32_bf16 v[252:255], v[124:127], v[148:151], v[252:255]
    ds_read_b64_tr_b16 v[98:99], v24 offset:18432
    s_waitcnt lgkmcnt(12)
    v_mfma_f32_16x16x32_bf16 v[160:163], v[64:67], v[128:131], v[160:163]
    ds_read_b128 v[144:147], v33 offset:2048
    v_mfma_f32_16x16x32_bf16 v[164:167], v[64:67], v[132:135], v[164:167]
    ds_read_b128 v[148:151], v33 offset:4096
    v_mfma_f32_16x16x32_bf16 v[168:171], v[64:67], v[136:139], v[168:171]
    ds_read_b64_tr_b16 v[100:101], v25 offset:16384
    v_mfma_f32_16x16x32_bf16 v[172:175], v[68:71], v[128:131], v[172:175]
    ds_read_b64_tr_b16 v[102:103], v25 offset:18432
    v_mfma_f32_16x16x32_bf16 v[176:179], v[68:71], v[132:135], v[176:179]
    ds_read_b64_tr_b16 v[104:105], v26 offset:16384
    v_mfma_f32_16x16x32_bf16 v[180:183], v[68:71], v[136:139], v[180:183]
    ds_read_b64_tr_b16 v[106:107], v26 offset:18432
    v_mfma_f32_16x16x32_bf16 v[184:187], v[72:75], v[128:131], v[184:187]
    ds_read_b64_tr_b16 v[108:109], v27 offset:16384
    v_mfma_f32_16x16x32_bf16 v[188:191], v[72:75], v[132:135], v[188:191]
    ds_read_b64_tr_b16 v[110:111], v27 offset:18432
    v_mfma_f32_16x16x32_bf16 v[192:195], v[72:75], v[136:139], v[192:195]
    ds_read_b64_tr_b16 v[112:113], v28 offset:16384
    s_waitcnt lgkmcnt(12)
    v_mfma_f32_16x16x32_bf16 v[196:199], v[76:79], v[128:131], v[196:199]
    ds_read_b64_tr_b16 v[114:115], v28 offset:18432
    v_mfma_f32_16x16x32_bf16 v[200:203], v[76:79], v[132:135], v[200:203]
    ds_read_b64_tr_b16 v[116:117], v29 offset:16384
    v_mfma_f32_16x16x32_bf16 v[204:207], v[76:79], v[136:139], v[204:207]
    ds_read_b64_tr_b16 v[118:119], v29 offset:18432
    v_mfma_f32_16x16x32_bf16 v[208:211], v[80:83], v[128:131], v[208:211]
    ds_read_b64_tr_b16 v[120:121], v30 offset:16384
    v_mfma_f32_16x16x32_bf16 v[212:215], v[80:83], v[132:135], v[212:215]
    ds_read_b64_tr_b16 v[122:123], v30 offset:18432
    v_mfma_f32_16x16x32_bf16 v[216:219], v[80:83], v[136:139], v[216:219]
    ds_read_b64_tr_b16 v[124:125], v31 offset:16384
    v_mfma_f32_16x16x32_bf16 v[220:223], v[84:87], v[128:131], v[220:223]
    ds_read_b64_tr_b16 v[126:127], v31 offset:18432
    v_mfma_f32_16x16x32_bf16 v[224:227], v[84:87], v[132:135], v[224:227]
    v_mfma_f32_16x16x32_bf16 v[228:231], v[84:87], v[136:139], v[228:231]
    v_mfma_f32_16x16x32_bf16 v[232:235], v[88:91], v[128:131], v[232:235]
    v_mfma_f32_16x16x32_bf16 v[236:239], v[88:91], v[132:135], v[236:239]
    v_mfma_f32_16x16x32_bf16 v[240:243], v[88:91], v[136:139], v[240:243]
    v_mfma_f32_16x16x32_bf16 v[244:247], v[92:95], v[128:131], v[244:247]
    v_mfma_f32_16x16x32_bf16 v[248:251], v[92:95], v[132:135], v[248:251]
    v_mfma_f32_16x16x32_bf16 v[252:255], v[92:95], v[136:139], v[252:255]
    s_waitcnt lgkmcnt(8)
    v_mfma_f32_16x16x32_bf16 v[160:163], v[96:99], v[140:143], v[160:163]
    v_mfma_f32_16x16x32_bf16 v[164:167], v[96:99], v[144:147], v[164:167]
    s_waitcnt lgkmcnt(0)
    s_barrier
    v_mfma_f32_16x16x32_bf16 v[168:171], v[96:99], v[148:151], v[168:171]
    ds_read_b128 v[128:131], v53 offset:0
    v_mfma_f32_16x16x32_bf16 v[172:175], v[100:103], v[140:143], v[172:175]
    ds_read_b64_tr_b16 v[64:65], v45 offset:0
    v_mfma_f32_16x16x32_bf16 v[176:179], v[100:103], v[144:147], v[176:179]
    ds_read_b64_tr_b16 v[66:67], v45 offset:2048
    v_mfma_f32_16x16x32_bf16 v[180:183], v[100:103], v[148:151], v[180:183]
    ds_read_b128 v[132:135], v53 offset:2048
    v_mfma_f32_16x16x32_bf16 v[184:187], v[104:107], v[140:143], v[184:187]
    ds_read_b128 v[136:139], v53 offset:4096
    v_mfma_f32_16x16x32_bf16 v[188:191], v[104:107], v[144:147], v[188:191]
    ds_read_b64_tr_b16 v[68:69], v46 offset:0
    v_mfma_f32_16x16x32_bf16 v[192:195], v[104:107], v[148:151], v[192:195]
    ds_read_b64_tr_b16 v[70:71], v46 offset:2048
    v_mfma_f32_16x16x32_bf16 v[196:199], v[108:111], v[140:143], v[196:199]
    ds_read_b64_tr_b16 v[72:73], v47 offset:0
    v_mfma_f32_16x16x32_bf16 v[200:203], v[108:111], v[144:147], v[200:203]
    ds_read_b64_tr_b16 v[74:75], v47 offset:2048
    v_mfma_f32_16x16x32_bf16 v[204:207], v[108:111], v[148:151], v[204:207]
    ds_read_b64_tr_b16 v[76:77], v48 offset:0
    v_mfma_f32_16x16x32_bf16 v[208:211], v[112:115], v[140:143], v[208:211]
    ds_read_b64_tr_b16 v[78:79], v48 offset:2048
    v_mfma_f32_16x16x32_bf16 v[212:215], v[112:115], v[144:147], v[212:215]
    ds_read_b64_tr_b16 v[80:81], v49 offset:0
    v_mfma_f32_16x16x32_bf16 v[216:219], v[112:115], v[148:151], v[216:219]
    ds_read_b64_tr_b16 v[82:83], v49 offset:2048
    v_mfma_f32_16x16x32_bf16 v[220:223], v[116:119], v[140:143], v[220:223]
    ds_read_b64_tr_b16 v[84:85], v50 offset:0
    v_mfma_f32_16x16x32_bf16 v[224:227], v[116:119], v[144:147], v[224:227]
    ds_read_b64_tr_b16 v[86:87], v50 offset:2048
    v_mfma_f32_16x16x32_bf16 v[228:231], v[116:119], v[148:151], v[228:231]
    ds_read_b64_tr_b16 v[88:89], v51 offset:0
    v_mfma_f32_16x16x32_bf16 v[232:235], v[120:123], v[140:143], v[232:235]
    ds_read_b64_tr_b16 v[90:91], v51 offset:2048
    v_mfma_f32_16x16x32_bf16 v[236:239], v[120:123], v[144:147], v[236:239]
    ds_read_b64_tr_b16 v[92:93], v52 offset:0
    v_mfma_f32_16x16x32_bf16 v[240:243], v[120:123], v[148:151], v[240:243]
    ds_read_b64_tr_b16 v[94:95], v52 offset:2048
    v_mfma_f32_16x16x32_bf16 v[244:247], v[124:127], v[140:143], v[244:247]
    ds_read_b128 v[140:143], v54 offset:0
    v_mfma_f32_16x16x32_bf16 v[248:251], v[124:127], v[144:147], v[248:251]
    ds_read_b64_tr_b16 v[96:97], v45 offset:16384
    v_mfma_f32_16x16x32_bf16 v[252:255], v[124:127], v[148:151], v[252:255]
    ds_read_b64_tr_b16 v[98:99], v45 offset:18432
    s_waitcnt lgkmcnt(12)
    v_mfma_f32_16x16x32_bf16 v[160:163], v[64:67], v[128:131], v[160:163]
    ds_read_b128 v[144:147], v54 offset:2048
    v_mfma_f32_16x16x32_bf16 v[164:167], v[64:67], v[132:135], v[164:167]
    ds_read_b128 v[148:151], v54 offset:4096
    v_mfma_f32_16x16x32_bf16 v[168:171], v[64:67], v[136:139], v[168:171]
    ds_read_b64_tr_b16 v[100:101], v46 offset:16384
    v_mfma_f32_16x16x32_bf16 v[172:175], v[68:71], v[128:131], v[172:175]
    ds_read_b64_tr_b16 v[102:103], v46 offset:18432
    v_mfma_f32_16x16x32_bf16 v[176:179], v[68:71], v[132:135], v[176:179]
    ds_read_b64_tr_b16 v[104:105], v47 offset:16384
    v_mfma_f32_16x16x32_bf16 v[180:183], v[68:71], v[136:139], v[180:183]
    ds_read_b64_tr_b16 v[106:107], v47 offset:18432
    v_mfma_f32_16x16x32_bf16 v[184:187], v[72:75], v[128:131], v[184:187]
    ds_read_b64_tr_b16 v[108:109], v48 offset:16384
    v_mfma_f32_16x16x32_bf16 v[188:191], v[72:75], v[132:135], v[188:191]
    ds_read_b64_tr_b16 v[110:111], v48 offset:18432
    v_mfma_f32_16x16x32_bf16 v[192:195], v[72:75], v[136:139], v[192:195]
    ds_read_b64_tr_b16 v[112:113], v49 offset:16384
    s_waitcnt lgkmcnt(12)
    v_mfma_f32_16x16x32_bf16 v[196:199], v[76:79], v[128:131], v[196:199]
    ds_read_b64_tr_b16 v[114:115], v49 offset:18432
    v_mfma_f32_16x16x32_bf16 v[200:203], v[76:79], v[132:135], v[200:203]
    ds_read_b64_tr_b16 v[116:117], v50 offset:16384
    v_mfma_f32_16x16x32_bf16 v[204:207], v[76:79], v[136:139], v[204:207]
    ds_read_b64_tr_b16 v[118:119], v50 offset:18432
    v_mfma_f32_16x16x32_bf16 v[208:211], v[80:83], v[128:131], v[208:211]
    ds_read_b64_tr_b16 v[120:121], v51 offset:16384
    v_mfma_f32_16x16x32_bf16 v[212:215], v[80:83], v[132:135], v[212:215]
    ds_read_b64_tr_b16 v[122:123], v51 offset:18432
    v_mfma_f32_16x16x32_bf16 v[216:219], v[80:83], v[136:139], v[216:219]
    ds_read_b64_tr_b16 v[124:125], v52 offset:16384
    v_mfma_f32_16x16x32_bf16 v[220:223], v[84:87], v[128:131], v[220:223]
    ds_read_b64_tr_b16 v[126:127], v52 offset:18432
    v_mfma_f32_16x16x32_bf16 v[224:227], v[84:87], v[132:135], v[224:227]
    v_mfma_f32_16x16x32_bf16 v[228:231], v[84:87], v[136:139], v[228:231]
    v_mfma_f32_16x16x32_bf16 v[232:235], v[88:91], v[128:131], v[232:235]
    v_mfma_f32_16x16x32_bf16 v[236:239], v[88:91], v[132:135], v[236:239]
    v_mfma_f32_16x16x32_bf16 v[240:243], v[88:91], v[136:139], v[240:243]
    v_mfma_f32_16x16x32_bf16 v[244:247], v[92:95], v[128:131], v[244:247]
    v_mfma_f32_16x16x32_bf16 v[248:251], v[92:95], v[132:135], v[248:251]
    v_mfma_f32_16x16x32_bf16 v[252:255], v[92:95], v[136:139], v[252:255]
    s_waitcnt lgkmcnt(8)
    v_mfma_f32_16x16x32_bf16 v[160:163], v[96:99], v[140:143], v[160:163]
    v_mfma_f32_16x16x32_bf16 v[164:167], v[96:99], v[144:147], v[164:167]
    s_waitcnt lgkmcnt(0)
    s_barrier
    v_mfma_f32_16x16x32_bf16 v[168:171], v[96:99], v[148:151], v[168:171]
    ds_read_b128 v[128:131], v2 offset:0
    v_mfma_f32_16x16x32_bf16 v[172:175], v[100:103], v[140:143], v[172:175]
    ds_read_b64_tr_b16 v[64:65], v55 offset:0
    v_mfma_f32_16x16x32_bf16 v[176:179], v[100:103], v[144:147], v[176:179]
    ds_read_b64_tr_b16 v[66:67], v55 offset:2048
    v_mfma_f32_16x16x32_bf16 v[180:183], v[100:103], v[148:151], v[180:183]
    ds_read_b128 v[132:135], v2 offset:2048
    v_mfma_f32_16x16x32_bf16 v[184:187], v[104:107], v[140:143], v[184:187]
    ds_read_b128 v[136:139], v2 offset:4096
    v_mfma_f32_16x16x32_bf16 v[188:191], v[104:107], v[144:147], v[188:191]
    ds_read_b64_tr_b16 v[68:69], v58 offset:0
    v_mfma_f32_16x16x32_bf16 v[192:195], v[104:107], v[148:151], v[192:195]
    ds_read_b64_tr_b16 v[70:71], v58 offset:2048
    v_mfma_f32_16x16x32_bf16 v[196:199], v[108:111], v[140:143], v[196:199]
    ds_read_b64_tr_b16 v[72:73], v59 offset:0
    v_mfma_f32_16x16x32_bf16 v[200:203], v[108:111], v[144:147], v[200:203]
    ds_read_b64_tr_b16 v[74:75], v59 offset:2048
    v_mfma_f32_16x16x32_bf16 v[204:207], v[108:111], v[148:151], v[204:207]
    ds_read_b64_tr_b16 v[76:77], v60 offset:0
    v_mfma_f32_16x16x32_bf16 v[208:211], v[112:115], v[140:143], v[208:211]
    ds_read_b64_tr_b16 v[78:79], v60 offset:2048
    v_mfma_f32_16x16x32_bf16 v[212:215], v[112:115], v[144:147], v[212:215]
    ds_read_b64_tr_b16 v[80:81], v61 offset:0
    v_mfma_f32_16x16x32_bf16 v[216:219], v[112:115], v[148:151], v[216:219]
    ds_read_b64_tr_b16 v[82:83], v61 offset:2048
    v_mfma_f32_16x16x32_bf16 v[220:223], v[116:119], v[140:143], v[220:223]
    ds_read_b64_tr_b16 v[84:85], v62 offset:0
    v_mfma_f32_16x16x32_bf16 v[224:227], v[116:119], v[144:147], v[224:227]
    ds_read_b64_tr_b16 v[86:87], v62 offset:2048
    v_and_b32 v2, 15, v0
    v_mfma_f32_16x16x32_bf16 v[228:231], v[116:119], v[148:151], v[228:231]
    ds_read_b64_tr_b16 v[88:89], v63 offset:0
    v_mul_u32_u24 v2, 2304, v2
    v_mfma_f32_16x16x32_bf16 v[232:235], v[120:123], v[140:143], v[232:235]
    ds_read_b64_tr_b16 v[90:91], v63 offset:2048
    v_mfma_f32_16x16x32_bf16 v[236:239], v[120:123], v[144:147], v[236:239]
    ds_read_b64_tr_b16 v[92:93], v1 offset:0
    v_mfma_f32_16x16x32_bf16 v[240:243], v[120:123], v[148:151], v[240:243]
    ds_read_b64_tr_b16 v[94:95], v1 offset:2048
    v_mfma_f32_16x16x32_bf16 v[244:247], v[124:127], v[140:143], v[244:247]
    ds_read_b128 v[140:143], v3 offset:0
    v_mfma_f32_16x16x32_bf16 v[248:251], v[124:127], v[144:147], v[248:251]
    ds_read_b64_tr_b16 v[96:97], v55 offset:16384
    v_mfma_f32_16x16x32_bf16 v[252:255], v[124:127], v[148:151], v[252:255]
    ds_read_b64_tr_b16 v[98:99], v55 offset:18432
    s_waitcnt lgkmcnt(11)
    v_mfma_f32_16x16x32_bf16 v[160:163], v[64:67], v[128:131], v[160:163]
    ds_read_b128 v[144:147], v3 offset:2048
    v_mfma_f32_16x16x32_bf16 v[164:167], v[64:67], v[132:135], v[164:167]
    ds_read_b128 v[148:151], v3 offset:4096
    v_mfma_f32_16x16x32_bf16 v[168:171], v[64:67], v[136:139], v[168:171]
    ds_read_b64_tr_b16 v[100:101], v58 offset:16384
    v_mfma_f32_16x16x32_bf16 v[172:175], v[68:71], v[128:131], v[172:175]
    ds_read_b64_tr_b16 v[102:103], v58 offset:18432
    v_mfma_f32_16x16x32_bf16 v[176:179], v[68:71], v[132:135], v[176:179]
    ds_read_b64_tr_b16 v[104:105], v59 offset:16384
    v_mfma_f32_16x16x32_bf16 v[180:183], v[68:71], v[136:139], v[180:183]
    ds_read_b64_tr_b16 v[106:107], v59 offset:18432
    v_mfma_f32_16x16x32_bf16 v[184:187], v[72:75], v[128:131], v[184:187]
    ds_read_b64_tr_b16 v[108:109], v60 offset:16384
    v_mfma_f32_16x16x32_bf16 v[188:191], v[72:75], v[132:135], v[188:191]
    ds_read_b64_tr_b16 v[110:111], v60 offset:18432
    v_mfma_f32_16x16x32_bf16 v[192:195], v[72:75], v[136:139], v[192:195]
    ds_read_b64_tr_b16 v[112:113], v61 offset:16384
    v_mfma_f32_16x16x32_bf16 v[196:199], v[76:79], v[128:131], v[196:199]
    ds_read_b64_tr_b16 v[114:115], v61 offset:18432
    v_mfma_f32_16x16x32_bf16 v[200:203], v[76:79], v[132:135], v[200:203]
    ds_read_b64_tr_b16 v[116:117], v62 offset:16384
    v_mfma_f32_16x16x32_bf16 v[204:207], v[76:79], v[136:139], v[204:207]
    ds_read_b64_tr_b16 v[118:119], v62 offset:18432
    v_bfe_u32 v3, v0, 4, 1
    s_waitcnt lgkmcnt(12)
    v_mfma_f32_16x16x32_bf16 v[208:211], v[80:83], v[128:131], v[208:211]
    ds_read_b64_tr_b16 v[120:121], v63 offset:16384
    v_lshl_add_u32 v2, v3, 5, v2
    v_mfma_f32_16x16x32_bf16 v[212:215], v[80:83], v[132:135], v[212:215]
    ds_read_b64_tr_b16 v[122:123], v63 offset:18432
    v_lshrrev_b32 v3, 5, v0
    v_mfma_f32_16x16x32_bf16 v[216:219], v[80:83], v[136:139], v[216:219]
    ds_read_b64_tr_b16 v[124:125], v1 offset:16384
    v_lshl_add_u32 v2, v3, 4, v2
    v_mfma_f32_16x16x32_bf16 v[220:223], v[84:87], v[128:131], v[220:223]
    ds_read_b64_tr_b16 v[126:127], v1 offset:18432
    v_mfma_f32_16x16x32_bf16 v[224:227], v[84:87], v[132:135], v[224:227]
    v_mfma_f32_16x16x32_bf16 v[228:231], v[84:87], v[136:139], v[228:231]
    v_mfma_f32_16x16x32_bf16 v[232:235], v[88:91], v[128:131], v[232:235]
    v_mfma_f32_16x16x32_bf16 v[236:239], v[88:91], v[132:135], v[236:239]
    v_mfma_f32_16x16x32_bf16 v[240:243], v[88:91], v[136:139], v[240:243]
    v_mfma_f32_16x16x32_bf16 v[244:247], v[92:95], v[128:131], v[244:247]
    v_mfma_f32_16x16x32_bf16 v[248:251], v[92:95], v[132:135], v[248:251]
    v_mfma_f32_16x16x32_bf16 v[252:255], v[92:95], v[136:139], v[252:255]
    v_mfma_f32_16x16x32_bf16 v[160:163], v[96:99], v[140:143], v[160:163]
    s_waitcnt lgkmcnt(5)
    v_mfma_f32_16x16x32_bf16 v[164:167], v[96:99], v[144:147], v[164:167]
    v_and_b32 v1, 3, v0
    s_waitcnt lgkmcnt(0)
    v_mfma_f32_16x16x32_bf16 v[168:171], v[96:99], v[148:151], v[168:171]
    s_barrier
    ds_read_b64 v[64:65], v37 offset:0
    v_mfma_f32_16x16x32_bf16 v[172:175], v[100:103], v[140:143], v[172:175]
    ds_read_b64 v[66:67], v38 offset:0
    v_cvt_pk_bf16_f32 v160, v160, v161
    v_mfma_f32_16x16x32_bf16 v[176:179], v[100:103], v[144:147], v[176:179]
    ds_read_b64 v[68:69], v37 offset:4096
    v_cvt_pk_bf16_f32 v161, v162, v163
    v_mfma_f32_16x16x32_bf16 v[180:183], v[100:103], v[148:151], v[180:183]
    ds_read_b64 v[70:71], v38 offset:4096
    v_cvt_pk_bf16_f32 v164, v164, v165
    v_mfma_f32_16x16x32_bf16 v[184:187], v[104:107], v[140:143], v[184:187]
    ds_read_b64 v[72:73], v37 offset:8192
    v_cvt_pk_bf16_f32 v162, v172, v173
    v_mfma_f32_16x16x32_bf16 v[188:191], v[104:107], v[144:147], v[188:191]
    ds_read_b64 v[74:75], v38 offset:8192
    v_cvt_pk_bf16_f32 v163, v174, v175
    v_mfma_f32_16x16x32_bf16 v[192:195], v[104:107], v[148:151], v[192:195]
    ds_read_b64 v[76:77], v39 offset:0
    v_cvt_pk_bf16_f32 v165, v166, v167
    v_mfma_f32_16x16x32_bf16 v[196:199], v[108:111], v[140:143], v[196:199]
    ds_read_b64 v[78:79], v40 offset:0
    v_cvt_pk_bf16_f32 v166, v176, v177
    v_mfma_f32_16x16x32_bf16 v[200:203], v[108:111], v[144:147], v[200:203]
    ds_read_b64 v[80:81], v39 offset:4096
    v_cvt_pk_bf16_f32 v167, v178, v179
    v_mfma_f32_16x16x32_bf16 v[204:207], v[108:111], v[148:151], v[204:207]
    ds_read_b64 v[82:83], v40 offset:4096
    v_cvt_pk_bf16_f32 v184, v184, v185
    v_mfma_f32_16x16x32_bf16 v[208:211], v[112:115], v[140:143], v[208:211]
    ds_read_b64 v[84:85], v39 offset:8192
    v_cvt_pk_bf16_f32 v185, v186, v187
    v_mfma_f32_16x16x32_bf16 v[212:215], v[112:115], v[144:147], v[212:215]
    ds_read_b64 v[86:87], v40 offset:8192
    v_cvt_pk_bf16_f32 v188, v188, v189
    v_mfma_f32_16x16x32_bf16 v[216:219], v[112:115], v[148:151], v[216:219]
    ds_read_b64 v[88:89], v41 offset:0
    v_cvt_pk_bf16_f32 v186, v196, v197
    v_mfma_f32_16x16x32_bf16 v[220:223], v[116:119], v[140:143], v[220:223]
    ds_read_b64 v[90:91], v42 offset:0
    v_cvt_pk_bf16_f32 v187, v198, v199
    v_mfma_f32_16x16x32_bf16 v[224:227], v[116:119], v[144:147], v[224:227]
    ds_read_b64 v[92:93], v41 offset:4096
    v_cvt_pk_bf16_f32 v189, v190, v191
    v_mfma_f32_16x16x32_bf16 v[228:231], v[116:119], v[148:151], v[228:231]
    ds_read_b64 v[94:95], v42 offset:4096
    v_cvt_pk_bf16_f32 v190, v200, v201
    v_mfma_f32_16x16x32_bf16 v[232:235], v[120:123], v[140:143], v[232:235]
    ds_read_b64 v[128:129], v41 offset:8192
    v_cvt_pk_bf16_f32 v191, v202, v203
    v_mfma_f32_16x16x32_bf16 v[236:239], v[120:123], v[144:147], v[236:239]
    ds_read_b64 v[130:131], v42 offset:8192
    v_cvt_pk_bf16_f32 v208, v208, v209
    v_mfma_f32_16x16x32_bf16 v[240:243], v[120:123], v[148:151], v[240:243]
    ds_read_b64 v[132:133], v43 offset:0
    v_cvt_pk_bf16_f32 v209, v210, v211
    v_mfma_f32_16x16x32_bf16 v[244:247], v[124:127], v[140:143], v[244:247]
    ds_read_b64 v[134:135], v44 offset:0
    v_cvt_pk_bf16_f32 v212, v212, v213
    v_mfma_f32_16x16x32_bf16 v[248:251], v[124:127], v[144:147], v[248:251]
    ds_read_b64 v[136:137], v43 offset:4096
    v_cvt_pk_bf16_f32 v210, v220, v221
    v_mfma_f32_16x16x32_bf16 v[252:255], v[124:127], v[148:151], v[252:255]
    ds_read_b64 v[138:139], v44 offset:4096
    v_cvt_pk_bf16_f32 v211, v222, v223
    s_waitcnt lgkmcnt(8)
    v_mfma_f32_16x16x32_bf16 v[96:99], v[64:67], v[160:163], 0
    ds_read_b64 v[156:157], v43 offset:8192
    v_cvt_pk_bf16_f32 v213, v214, v215
    v_mfma_f32_16x16x32_bf16 v[100:103], v[68:71], v[160:163], 0
    ds_read_b64 v[158:159], v44 offset:8192
    v_cvt_pk_bf16_f32 v214, v224, v225
    v_mfma_f32_16x16x32_bf16 v[104:107], v[72:75], v[160:163], 0
    v_cvt_pk_bf16_f32 v215, v226, v227
    v_cvt_pk_bf16_f32 v232, v232, v233
    v_mfma_f32_16x16x32_bf16 v[96:99], v[76:79], v[184:187], v[96:99]
    v_cvt_pk_bf16_f32 v233, v234, v235
    v_cvt_pk_bf16_f32 v236, v236, v237
    v_mfma_f32_16x16x32_bf16 v[100:103], v[80:83], v[184:187], v[100:103]
    v_cvt_pk_bf16_f32 v234, v244, v245
    v_cvt_pk_bf16_f32 v235, v246, v247
    v_mfma_f32_16x16x32_bf16 v[104:107], v[84:87], v[184:187], v[104:107]
    v_cvt_pk_bf16_f32 v237, v238, v239
    v_cvt_pk_bf16_f32 v238, v248, v249
    v_mfma_f32_16x16x32_bf16 v[96:99], v[88:91], v[208:211], v[96:99]
    v_cvt_pk_bf16_f32 v239, v250, v251
    v_cvt_pk_bf16_f32 v168, v168, v169
    s_waitcnt lgkmcnt(3)
    v_mfma_f32_16x16x32_bf16 v[100:103], v[92:95], v[208:211], v[100:103]
    v_cvt_pk_bf16_f32 v169, v170, v171
    v_cvt_pk_bf16_f32 v170, v180, v181
    v_mfma_f32_16x16x32_bf16 v[104:107], v[128:131], v[208:211], v[104:107]
    v_cvt_pk_bf16_f32 v171, v182, v183
    v_cvt_pk_bf16_f32 v192, v192, v193
    v_mfma_f32_16x16x32_bf16 v[96:99], v[132:135], v[232:235], v[96:99]
    v_cvt_pk_bf16_f32 v193, v194, v195
    v_cvt_pk_bf16_f32 v194, v204, v205
    s_waitcnt lgkmcnt(0)
    v_mfma_f32_16x16x32_bf16 v[100:103], v[136:139], v[232:235], v[100:103]
    v_cvt_pk_bf16_f32 v195, v206, v207
    v_cvt_pk_bf16_f32 v216, v216, v217
    v_mfma_f32_16x16x32_bf16 v[104:107], v[156:159], v[232:235], v[104:107]
    v_cvt_pk_bf16_f32 v217, v218, v219
    v_cvt_pk_bf16_f32 v218, v228, v229
    v_mfma_f32_16x16x32_bf16 v[108:111], v[64:67], v[164:167], 0
    v_cvt_pk_bf16_f32 v219, v230, v231
    v_max3_f32 v48, v96, v97, v98
    v_mfma_f32_16x16x32_bf16 v[112:115], v[68:71], v[164:167], 0
    v_cvt_pk_bf16_f32 v240, v240, v241
    v_max3_f32 v49, v99, v100, v101
    v_mfma_f32_16x16x32_bf16 v[116:119], v[72:75], v[164:167], 0
    v_max3_f32 v48, v48, v102, v103
    v_max3_f32 v49, v49, v104, v105
    v_mfma_f32_16x16x32_bf16 v[108:111], v[76:79], v[188:191], v[108:111]
    v_max3_f32 v48, v48, v106, v107
    v_max_f32 v48, v48, v49
    v_mfma_f32_16x16x32_bf16 v[112:115], v[80:83], v[188:191], v[112:115]
    v_mov_b32 v49, v48
    v_cvt_pk_bf16_f32 v241, v242, v243
    v_mfma_f32_16x16x32_bf16 v[116:119], v[84:87], v[188:191], v[116:119]
    v_permlane32_swap_b32 v49, v48
    v_cvt_pk_bf16_f32 v242, v252, v253
    v_mfma_f32_16x16x32_bf16 v[108:111], v[88:91], v[212:215], v[108:111]
    v_cvt_pk_bf16_f32 v243, v254, v255
    v_max_f32 v48, v48, v49
    v_mfma_f32_16x16x32_bf16 v[112:115], v[92:95], v[212:215], v[112:115]
    v_mov_b32 v49, v48
    v_min_u32 v1, 2, v1
    v_mfma_f32_16x16x32_bf16 v[116:119], v[128:131], v[212:215], v[116:119]
    v_permlane16_swap_b32 v49, v48
    v_max_f32 v48, v48, v49
    v_mfma_f32_16x16x32_bf16 v[108:111], v[132:135], v[236:239], v[108:111]
    v_mul_f32 v48, s72, v48
    v_pk_fma_f32 v[96:97], v[96:97], s[72:73], v[48:49] op_sel_hi:[1,1,0] neg_lo:[0,0,1] neg_hi:[0,0,1]
    v_mfma_f32_16x16x32_bf16 v[112:115], v[136:139], v[236:239], v[112:115]
    v_pk_fma_f32 v[98:99], v[98:99], s[72:73], v[48:49] op_sel_hi:[1,1,0] neg_lo:[0,0,1] neg_hi:[0,0,1]
    v_pk_fma_f32 v[100:101], v[100:101], s[72:73], v[48:49] op_sel_hi:[1,1,0] neg_lo:[0,0,1] neg_hi:[0,0,1]
    v_mfma_f32_16x16x32_bf16 v[116:119], v[156:159], v[236:239], v[116:119]
    v_pk_fma_f32 v[102:103], v[102:103], s[72:73], v[48:49] op_sel_hi:[1,1,0] neg_lo:[0,0,1] neg_hi:[0,0,1]
    v_pk_fma_f32 v[104:105], v[104:105], s[72:73], v[48:49] op_sel_hi:[1,1,0] neg_lo:[0,0,1] neg_hi:[0,0,1]
    v_mfma_f32_16x16x32_bf16 v[120:123], v[64:67], v[168:171], 0
    v_pk_fma_f32 v[106:107], v[106:107], s[72:73], v[48:49] op_sel_hi:[1,1,0] neg_lo:[0,0,1] neg_hi:[0,0,1]
    v_max3_f32 v50, v108, v109, v110
    v_mfma_f32_16x16x32_bf16 v[124:127], v[68:71], v[168:171], 0
    v_exp_f32 v96, v96
    v_max3_f32 v51, v111, v112, v113
    v_mfma_f32_16x16x32_bf16 v[140:143], v[72:75], v[168:171], 0
    v_max3_f32 v50, v50, v114, v115
    v_max3_f32 v51, v51, v116, v117
    v_mfma_f32_16x16x32_bf16 v[120:123], v[76:79], v[192:195], v[120:123]
    v_max3_f32 v50, v50, v118, v119
    v_max_f32 v50, v50, v51
    v_mfma_f32_16x16x32_bf16 v[124:127], v[80:83], v[192:195], v[124:127]
    v_mov_b32 v51, v50
    v_exp_f32 v97, v97
    v_mfma_f32_16x16x32_bf16 v[140:143], v[84:87], v[192:195], v[140:143]
    v_permlane32_swap_b32 v51, v50
    v_max_f32 v50, v50, v51
    v_mfma_f32_16x16x32_bf16 v[120:123], v[88:91], v[216:219], v[120:123]
    v_mov_b32 v51, v50
    v_exp_f32 v98, v98
    v_mfma_f32_16x16x32_bf16 v[124:127], v[92:95], v[216:219], v[124:127]
    v_permlane16_swap_b32 v51, v50
    v_max_f32 v50, v50, v51
    v_mfma_f32_16x16x32_bf16 v[140:143], v[128:131], v[216:219], v[140:143]
    v_mul_f32 v50, s72, v50
    v_exp_f32 v99, v99
    v_mfma_f32_16x16x32_bf16 v[120:123], v[132:135], v[240:243], v[120:123]
    v_exp_f32 v100, v100
    v_exp_f32 v101, v101
    v_mfma_f32_16x16x32_bf16 v[124:127], v[136:139], v[240:243], v[124:127]
    v_exp_f32 v102, v102
    v_exp_f32 v103, v103
    v_mfma_f32_16x16x32_bf16 v[140:143], v[156:159], v[240:243], v[140:143]
    v_pk_fma_f32 v[108:109], v[108:109], s[72:73], v[50:51] op_sel_hi:[1,1,0] neg_lo:[0,0,1] neg_hi:[0,0,1]
    v_pk_fma_f32 v[110:111], v[110:111], s[72:73], v[50:51] op_sel_hi:[1,1,0] neg_lo:[0,0,1] neg_hi:[0,0,1]
    v_pk_fma_f32 v[112:113], v[112:113], s[72:73], v[50:51] op_sel_hi:[1,1,0] neg_lo:[0,0,1] neg_hi:[0,0,1]
    v_pk_fma_f32 v[114:115], v[114:115], s[72:73], v[50:51] op_sel_hi:[1,1,0] neg_lo:[0,0,1] neg_hi:[0,0,1]
    v_exp_f32 v104, v104
    v_exp_f32 v105, v105
    v_exp_f32 v106, v106
    v_exp_f32 v107, v107
    v_pk_fma_f32 v[116:117], v[116:117], s[72:73], v[50:51] op_sel_hi:[1,1,0] neg_lo:[0,0,1] neg_hi:[0,0,1]
    v_pk_fma_f32 v[118:119], v[118:119], s[72:73], v[50:51] op_sel_hi:[1,1,0] neg_lo:[0,0,1] neg_hi:[0,0,1]
    v_exp_f32 v108, v108
    v_exp_f32 v109, v109
    v_exp_f32 v110, v110
    v_exp_f32 v111, v111
    v_exp_f32 v112, v112
    v_exp_f32 v113, v113
    v_exp_f32 v114, v114
    v_exp_f32 v115, v115
    v_pk_add_f32 v[62:63], v[96:97], v[98:99]
    v_pk_add_f32 v[144:145], v[100:101], v[102:103]
    v_exp_f32 v116, v116
    v_exp_f32 v117, v117
    v_exp_f32 v118, v118
    v_exp_f32 v119, v119
    v_pk_add_f32 v[62:63], v[62:63], v[104:105]
    v_pk_add_f32 v[144:145], v[144:145], v[106:107]
    v_pk_add_f32 v[146:147], v[108:109], v[110:111]
    v_pk_add_f32 v[148:149], v[112:113], v[114:115]
    v_pk_add_f32 v[62:63], v[62:63], v[144:145]
    v_pk_add_f32 v[146:147], v[146:147], v[116:117]
    v_pk_add_f32 v[148:149], v[148:149], v[118:119]
    v_max3_f32 v52, v120, v121, v122
    v_add_f32 v54, v62, v63
    v_pk_add_f32 v[146:147], v[146:147], v[148:149]
    v_max3_f32 v53, v123, v124, v125
    v_max3_f32 v52, v52, v126, v127
    v_mov_b32 v55, v54
    v_add_f32 v58, v146, v147
    v_max3_f32 v53, v53, v140, v141
    v_max3_f32 v52, v52, v142, v143
    v_mov_b32 v59, v58
    v_max_f32 v52, v52, v53
    v_permlane32_swap_b32 v55, v54
    v_mov_b32 v53, v52
    s_barrier
    v_add_f32 v54, v54, v55
    v_permlane32_swap_b32 v59, v58
    ds_read_b128 v[200:203], v8 offset:0
    v_mov_b32 v55, v54
    v_add_f32 v58, v58, v59
    v_permlane32_swap_b32 v53, v52
    ds_read_b128 v[204:207], v8 offset:4096
    v_mov_b32 v59, v58
    v_max_f32 v52, v52, v53
    v_permlane16_swap_b32 v55, v54
    ds_read_b128 v[208:211], v8 offset:8192
    v_mov_b32 v53, v52
    v_add_f32 v54, v54, v55
    v_permlane16_swap_b32 v59, v58
    ds_read_b64_tr_b16 v[224:225], v56 offset:0
    v_rcp_f32 v54, v54
    ds_read_b64_tr_b16 v[226:227], v56 offset:512
    v_add_f32 v58, v58, v59
    ds_read_b64_tr_b16 v[228:229], v57 offset:0
    v_permlane16_swap_b32 v53, v52
    ds_read_b64_tr_b16 v[230:231], v57 offset:512
    v_rcp_f32 v58, v58
    ds_read_b128 v[212:215], v9 offset:0
    v_max_f32 v52, v52, v53
    v_pk_mul_f32 v[96:97], v[96:97], v[54:55] op_sel_hi:[1,0]
    v_mul_f32 v52, s72, v52
    ds_read_b128 v[216:219], v9 offset:4096
    v_pk_mul_f32 v[98:99], v[98:99], v[54:55] op_sel_hi:[1,0]
    v_cvt_pk_bf16_f32 v96, v96, v97
    v_pk_mul_f32 v[108:109], v[108:109], v[58:59] op_sel_hi:[1,0]
    ds_read_b128 v[220:223], v9 offset:8192
    v_pk_fma_f32 v[120:121], v[120:121], s[72:73], v[52:53] op_sel_hi:[1,1,0] neg_lo:[0,0,1] neg_hi:[0,0,1]
    v_pk_fma_f32 v[122:123], v[122:123], s[72:73], v[52:53] op_sel_hi:[1,1,0] neg_lo:[0,0,1] neg_hi:[0,0,1]
    v_pk_fma_f32 v[124:125], v[124:125], s[72:73], v[52:53] op_sel_hi:[1,1,0] neg_lo:[0,0,1] neg_hi:[0,0,1]
    ds_read_b64_tr_b16 v[232:233], v56 offset:4096
    v_pk_fma_f32 v[126:127], v[126:127], s[72:73], v[52:53] op_sel_hi:[1,1,0] neg_lo:[0,0,1] neg_hi:[0,0,1]
    ds_read_b64_tr_b16 v[234:235], v56 offset:4608
    v_pk_mul_f32 v[104:105], v[104:105], v[54:55] op_sel_hi:[1,0]
    ds_read_b64_tr_b16 v[236:237], v57 offset:4096
    v_pk_mul_f32 v[100:101], v[100:101], v[54:55] op_sel_hi:[1,0]
    ds_read_b64_tr_b16 v[238:239], v57 offset:4608
    v_pk_mul_f32 v[102:103], v[102:103], v[54:55] op_sel_hi:[1,0]
    ds_read_b128 v[176:179], v10 offset:0
    v_cvt_pk_bf16_f32 v97, v98, v99
    v_pk_mul_f32 v[110:111], v[110:111], v[58:59] op_sel_hi:[1,0]
    v_pk_mul_f32 v[106:107], v[106:107], v[54:55] op_sel_hi:[1,0]
    ds_read_b128 v[180:183], v10 offset:4096
    v_cvt_pk_bf16_f32 v108, v108, v109
    v_pk_fma_f32 v[140:141], v[140:141], s[72:73], v[52:53] op_sel_hi:[1,1,0] neg_lo:[0,0,1] neg_hi:[0,0,1]
    v_pk_fma_f32 v[142:143], v[142:143], s[72:73], v[52:53] op_sel_hi:[1,1,0] neg_lo:[0,0,1] neg_hi:[0,0,1]
    ds_read_b128 v[184:187], v10 offset:8192
    v_exp_f32 v120, v120
    v_exp_f32 v121, v121
    ds_read_b128 v[188:191], v11 offset:0
    v_exp_f32 v122, v122
    v_exp_f32 v123, v123
    v_exp_f32 v124, v124
    v_exp_f32 v125, v125
    v_exp_f32 v126, v126
    v_exp_f32 v127, v127
    v_cvt_pk_bf16_f32 v104, v104, v105
    v_pk_mul_f32 v[116:117], v[116:117], v[58:59] op_sel_hi:[1,0]
    ds_read_b128 v[192:195], v11 offset:4096
    v_cvt_pk_bf16_f32 v98, v100, v101
    v_cvt_pk_bf16_f32 v99, v102, v103
    s_waitcnt lgkmcnt(5)
    v_mfma_f32_16x16x32_bf16 v[100:103], v[204:207], v[224:227], 0
    v_pk_mul_f32 v[112:113], v[112:113], v[58:59] op_sel_hi:[1,0]
    v_pk_mul_f32 v[114:115], v[114:115], v[58:59] op_sel_hi:[1,0]
    v_cvt_pk_bf16_f32 v109, v110, v111
    v_mfma_f32_16x16x32_bf16 v[100:103], v[216:219], v[232:235], v[100:103]
    ds_read_b128 v[196:199], v11 offset:8192
    v_cvt_pk_bf16_f32 v105, v106, v107
    v_pk_mul_f32 v[118:119], v[118:119], v[58:59] op_sel_hi:[1,0]
    v_exp_f32 v140, v140
    v_exp_f32 v141, v141
    v_exp_f32 v142, v142
    v_exp_f32 v143, v143
    v_cvt_pk_bf16_f32 v116, v116, v117
    ds_write_b128 v4, v[96:99] offset:0
    v_cvt_pk_bf16_f32 v110, v112, v113
    v_cvt_pk_bf16_f32 v111, v114, v115
    v_mfma_f32_16x16x32_bf16 v[112:115], v[204:207], v[228:231], 0
    v_cvt_pk_bf16_f32 v117, v118, v119
    v_pk_add_f32 v[150:151], v[120:121], v[122:123]
    v_pk_add_f32 v[152:153], v[124:125], v[126:127]
    v_mfma_f32_16x16x32_bf16 v[112:115], v[216:219], v[236:239], v[112:115]
    ds_write_b64 v155, v[104:105] offset:12288
    v_pk_add_f32 v[150:151], v[150:151], v[140:141]
    v_pk_add_f32 v[152:153], v[152:153], v[142:143]
    v_pk_add_f32 v[150:151], v[150:151], v[152:153]
    ds_write_b128 v4, v[108:111] offset:1024
    v_add_f32 v60, v150, v151
    v_mov_b32 v61, v60
    v_add3_u32 v1, v1, s53, 1
    v_and_b32 v1, 3, v1
    v_permlane32_swap_b32 v61, v60
    v_add_f32 v60, v60, v61
    v_mov_b32 v61, v60
    ds_write_b64 v155, v[116:117] offset:13312
    v_lshlrev_b32 v1, 3, v1
    v_permlane16_swap_b32 v61, v60
    v_add_f32 v60, v60, v61
    v_rcp_f32 v60, v60
    s_nop 0
    v_pk_mul_f32 v[120:121], v[120:121], v[60:61] op_sel_hi:[1,0]
    v_pk_mul_f32 v[122:123], v[122:123], v[60:61] op_sel_hi:[1,0]
    v_cvt_pk_bf16_f32 v120, v120, v121
    v_pk_mul_f32 v[140:141], v[140:141], v[60:61] op_sel_hi:[1,0]
    v_pk_mul_f32 v[124:125], v[124:125], v[60:61] op_sel_hi:[1,0]
    v_pk_mul_f32 v[126:127], v[126:127], v[60:61] op_sel_hi:[1,0]
    v_mfma_f32_16x16x32_bf16 v[96:99], v[200:203], v[224:227], 0
    v_cvt_pk_bf16_f32 v121, v122, v123
    v_pk_mul_f32 v[142:143], v[142:143], v[60:61] op_sel_hi:[1,0]
    v_cvt_pk_bf16_f32 v140, v140, v141
    v_mfma_f32_16x16x32_bf16 v[96:99], v[212:215], v[232:235], v[96:99]
    v_cvt_pk_bf16_f32 v122, v124, v125
    v_cvt_pk_bf16_f32 v123, v126, v127
    v_cvt_pk_bf16_f32 v141, v142, v143
    v_mfma_f32_16x16x32_bf16 v[104:107], v[208:211], v[224:227], 0
    ds_write_b128 v4, v[120:123] offset:2048
    v_mfma_f32_16x16x32_bf16 v[104:107], v[220:223], v[232:235], v[104:107]
    v_mfma_f32_16x16x32_bf16 v[108:111], v[200:203], v[228:231], 0
    ds_write_b64 v155, v[140:141] offset:14336
    s_waitcnt lgkmcnt(0)
    v_mfma_f32_16x16x32_bf16 v[108:111], v[212:215], v[236:239], v[108:111]
    s_barrier
    ds_read_b64_tr_b16 v[240:241], v56 offset:8192
    v_mfma_f32_16x16x32_bf16 v[116:119], v[208:211], v[228:231], 0
    ds_read_b64_tr_b16 v[242:243], v56 offset:8704
    ds_read_b64_tr_b16 v[244:245], v57 offset:8192
    v_mfma_f32_16x16x32_bf16 v[116:119], v[220:223], v[236:239], v[116:119]
    ds_read_b64_tr_b16 v[246:247], v57 offset:8704
    ds_read_b64_tr_b16 v[248:249], v56 offset:12288
    ds_read_b64_tr_b16 v[250:251], v56 offset:12800
    ds_read_b64_tr_b16 v[252:253], v57 offset:12288
    ds_read_b64_tr_b16 v[254:255], v57 offset:12800
    ds_read_b64_tr_b16 v[224:225], v56 offset:20480
    ds_read_b64_tr_b16 v[226:227], v56 offset:20992
    ds_read_b64_tr_b16 v[228:229], v57 offset:20480
    ds_read_b64_tr_b16 v[230:231], v57 offset:20992
    ds_read_b64_tr_b16 v[232:233], v56 offset:24576
    s_waitcnt lgkmcnt(11)
    v_mfma_f32_16x16x32_bf16 v[96:99], v[176:179], v[240:243], v[96:99]
    ds_read_b64_tr_b16 v[234:235], v56 offset:25088
    v_mfma_f32_16x16x32_bf16 v[100:103], v[180:183], v[240:243], v[100:103]
    ds_read_b64_tr_b16 v[236:237], v57 offset:24576
    v_mfma_f32_16x16x32_bf16 v[104:107], v[184:187], v[240:243], v[104:107]
    ds_read_b64_tr_b16 v[238:239], v57 offset:25088
    s_waitcnt lgkmcnt(12)
    v_mfma_f32_16x16x32_bf16 v[108:111], v[176:179], v[244:247], v[108:111]
    ds_read_b64_tr_b16 v[240:241], v56 offset:28672
    v_mfma_f32_16x16x32_bf16 v[112:115], v[180:183], v[244:247], v[112:115]
    ds_read_b64_tr_b16 v[242:243], v56 offset:29184
    v_mfma_f32_16x16x32_bf16 v[116:119], v[184:187], v[244:247], v[116:119]
    ds_read_b64_tr_b16 v[244:245], v57 offset:28672
    s_waitcnt lgkmcnt(13)
    v_mfma_f32_16x16x32_bf16 v[96:99], v[188:191], v[248:251], v[96:99]
    ds_read_b64_tr_b16 v[246:247], v57 offset:29184
    v_mfma_f32_16x16x32_bf16 v[100:103], v[192:195], v[248:251], v[100:103]
    v_mfma_f32_16x16x32_bf16 v[104:107], v[196:199], v[248:251], v[104:107]
    ds_read_b64_tr_b16 v[248:249], v56 offset:32768
    s_waitcnt lgkmcnt(12)
    v_mfma_f32_16x16x32_bf16 v[108:111], v[188:191], v[252:255], v[108:111]
    ds_read_b64_tr_b16 v[250:251], v56 offset:33280
    s_nop 0
    v_cvt_pk_bf16_f32 v24, v96, v97
    v_mfma_f32_16x16x32_bf16 v[112:115], v[192:195], v[252:255], v[112:115]
    v_cvt_pk_bf16_f32 v25, v98, v99
    v_cvt_pk_bf16_f32 v26, v100, v101
    v_mfma_f32_16x16x32_bf16 v[116:119], v[196:199], v[252:255], v[116:119]
    v_cvt_pk_bf16_f32 v27, v102, v103
    ds_read_b64_tr_b16 v[252:253], v57 offset:32768
    s_waitcnt lgkmcnt(7)
    v_mfma_f32_16x16x32_bf16 v[120:123], v[200:203], v[224:227], 0
    ds_read_b64_tr_b16 v[254:255], v57 offset:33280
    v_cvt_pk_bf16_f32 v40, v104, v105
    v_mfma_f32_16x16x32_bf16 v[124:127], v[204:207], v[224:227], 0
    v_cvt_pk_bf16_f32 v41, v106, v107
    v_cvt_pk_bf16_f32 v28, v108, v109
    v_mfma_f32_16x16x32_bf16 v[128:131], v[208:211], v[224:227], 0
    v_cvt_pk_bf16_f32 v29, v110, v111
    v_cvt_pk_bf16_f32 v30, v112, v113
    v_mfma_f32_16x16x32_bf16 v[132:135], v[200:203], v[228:231], 0
    v_cvt_pk_bf16_f32 v31, v114, v115
    v_cvt_pk_bf16_f32 v44, v116, v117
    v_mfma_f32_16x16x32_bf16 v[136:139], v[204:207], v[228:231], 0
    v_cvt_pk_bf16_f32 v45, v118, v119
    v_mfma_f32_16x16x32_bf16 v[140:143], v[208:211], v[228:231], 0
    v_mfma_f32_16x16x32_bf16 v[120:123], v[212:215], v[232:235], v[120:123]
    v_mfma_f32_16x16x32_bf16 v[124:127], v[216:219], v[232:235], v[124:127]
    v_mfma_f32_16x16x32_bf16 v[128:131], v[220:223], v[232:235], v[128:131]
    v_mfma_f32_16x16x32_bf16 v[132:135], v[212:215], v[236:239], v[132:135]
    v_mfma_f32_16x16x32_bf16 v[136:139], v[216:219], v[236:239], v[136:139]
    v_mfma_f32_16x16x32_bf16 v[140:143], v[220:223], v[236:239], v[140:143]
    s_waitcnt lgkmcnt(2)
    v_mfma_f32_16x16x32_bf16 v[120:123], v[176:179], v[240:243], v[120:123]
    v_mfma_f32_16x16x32_bf16 v[124:127], v[180:183], v[240:243], v[124:127]
    s_waitcnt lgkmcnt(0)
    s_barrier
    v_mfma_f32_16x16x32_bf16 v[128:131], v[184:187], v[240:243], v[128:131]
    ds_read_b64_tr_b16 v[224:225], v16 offset:36864
    v_mfma_f32_16x16x32_bf16 v[132:135], v[176:179], v[244:247], v[132:135]
    ds_read_b64_tr_b16 v[226:227], v16 offset:37888
    v_mfma_f32_16x16x32_bf16 v[136:139], v[180:183], v[244:247], v[136:139]
    ds_read_b64_tr_b16 v[228:229], v17 offset:36864
    v_mfma_f32_16x16x32_bf16 v[140:143], v[184:187], v[244:247], v[140:143]
    ds_read_b64_tr_b16 v[230:231], v17 offset:37888
    v_mfma_f32_16x16x32_bf16 v[120:123], v[188:191], v[248:251], v[120:123]
    ds_read_b64_tr_b16 v[232:233], v18 offset:36864
    v_mfma_f32_16x16x32_bf16 v[124:127], v[192:195], v[248:251], v[124:127]
    ds_read_b64_tr_b16 v[234:235], v18 offset:37888
    v_mfma_f32_16x16x32_bf16 v[128:131], v[196:199], v[248:251], v[128:131]
    ds_read_b64_tr_b16 v[236:237], v19 offset:36864
    v_mfma_f32_16x16x32_bf16 v[132:135], v[188:191], v[252:255], v[132:135]
    ds_read_b64_tr_b16 v[238:239], v19 offset:37888
    s_nop 0
    v_cvt_pk_bf16_f32 v32, v120, v121
    v_mfma_f32_16x16x32_bf16 v[136:139], v[192:195], v[252:255], v[136:139]
    ds_read_b64_tr_b16 v[240:241], v16 offset:45056
    v_cvt_pk_bf16_f32 v33, v122, v123
    v_mfma_f32_16x16x32_bf16 v[140:143], v[196:199], v[252:255], v[140:143]
    ds_read_b64_tr_b16 v[242:243], v16 offset:46080
    v_cvt_pk_bf16_f32 v34, v124, v125
    s_waitcnt lgkmcnt(8)
    v_mfma_f32_16x16x32_bf16 v[96:99], v[200:203], v[224:227], 0
    ds_read_b64_tr_b16 v[244:245], v17 offset:45056
    v_cvt_pk_bf16_f32 v35, v126, v127
    v_mfma_f32_16x16x32_bf16 v[100:103], v[204:207], v[224:227], 0
    ds_read_b64_tr_b16 v[246:247], v17 offset:46080
    v_cvt_pk_bf16_f32 v42, v128, v129
    v_mfma_f32_16x16x32_bf16 v[104:107], v[208:211], v[224:227], 0
    ds_read_b64_tr_b16 v[248:249], v18 offset:45056
    v_cvt_pk_bf16_f32 v43, v130, v131
    s_waitcnt lgkmcnt(8)
    v_mfma_f32_16x16x32_bf16 v[108:111], v[200:203], v[228:231], 0
    ds_read_b64_tr_b16 v[250:251], v18 offset:46080
    v_cvt_pk_bf16_f32 v36, v132, v133
    v_mfma_f32_16x16x32_bf16 v[112:115], v[204:207], v[228:231], 0
    ds_read_b64_tr_b16 v[252:253], v19 offset:45056
    v_cvt_pk_bf16_f32 v37, v134, v135
    v_mfma_f32_16x16x32_bf16 v[116:119], v[208:211], v[228:231], 0
    v_cvt_pk_bf16_f32 v38, v136, v137
    v_cvt_pk_bf16_f32 v39, v138, v139
    s_waitcnt lgkmcnt(6)
    v_mfma_f32_16x16x32_bf16 v[120:123], v[200:203], v[232:235], 0
    v_cvt_pk_bf16_f32 v46, v140, v141
    v_cvt_pk_bf16_f32 v47, v142, v143
    v_mfma_f32_16x16x32_bf16 v[124:127], v[204:207], v[232:235], 0
    ds_read_b64_tr_b16 v[254:255], v19 offset:46080
    v_mfma_f32_16x16x32_bf16 v[128:131], v[208:211], v[232:235], 0
    ds_read_b64_tr_b16 v[224:225], v20 offset:0
    v_mfma_f32_16x16x32_bf16 v[132:135], v[200:203], v[236:239], 0
    ds_read_b64_tr_b16 v[226:227], v20 offset:1024
    v_mfma_f32_16x16x32_bf16 v[136:139], v[204:207], v[236:239], 0
    ds_read_b64_tr_b16 v[228:229], v21 offset:0
    v_mfma_f32_16x16x32_bf16 v[140:143], v[208:211], v[236:239], 0
    ds_read_b64_tr_b16 v[230:231], v21 offset:1024
    s_waitcnt lgkmcnt(7)
    v_mfma_f32_16x16x32_bf16 v[96:99], v[212:215], v[240:243], v[96:99]
    ds_read_b64_tr_b16 v[232:233], v22 offset:0
    v_mfma_f32_16x16x32_bf16 v[100:103], v[216:219], v[240:243], v[100:103]
    ds_read_b64_tr_b16 v[234:235], v22 offset:1024
    v_mfma_f32_16x16x32_bf16 v[104:107], v[220:223], v[240:243], v[104:107]
    ds_read_b64_tr_b16 v[236:237], v23 offset:0
    v_mfma_f32_16x16x32_bf16 v[108:111], v[212:215], v[244:247], v[108:111]
    ds_read_b64_tr_b16 v[238:239], v23 offset:1024
    v_mfma_f32_16x16x32_bf16 v[112:115], v[216:219], v[244:247], v[112:115]
    ds_read_b128 v[200:203], v5 offset:0
    v_mfma_f32_16x16x32_bf16 v[116:119], v[220:223], v[244:247], v[116:119]
    ds_read_b128 v[204:207], v5 offset:1024
    s_waitcnt lgkmcnt(11)
    v_mfma_f32_16x16x32_bf16 v[120:123], v[212:215], v[248:251], v[120:123]
    ds_read_b128 v[208:211], v5 offset:2048
    v_mfma_f32_16x16x32_bf16 v[124:127], v[216:219], v[248:251], v[124:127]
    ds_read_b64_tr_b16 v[240:241], v20 offset:8192
    v_mfma_f32_16x16x32_bf16 v[128:131], v[220:223], v[248:251], v[128:131]
    ds_read_b64_tr_b16 v[242:243], v20 offset:9216
    s_waitcnt lgkmcnt(11)
    v_mfma_f32_16x16x32_bf16 v[132:135], v[212:215], v[252:255], v[132:135]
    ds_read_b64_tr_b16 v[244:245], v21 offset:8192
    v_mfma_f32_16x16x32_bf16 v[136:139], v[216:219], v[252:255], v[136:139]
    ds_read_b64_tr_b16 v[246:247], v21 offset:9216
    v_mfma_f32_16x16x32_bf16 v[140:143], v[220:223], v[252:255], v[140:143]
    ds_read_b64_tr_b16 v[248:249], v22 offset:8192
    v_mfma_f32_16x16x32_bf16 v[96:99], v[176:179], v[224:227], v[96:99]
    ds_read_b64_tr_b16 v[250:251], v22 offset:9216
    v_mfma_f32_16x16x32_bf16 v[100:103], v[180:183], v[224:227], v[100:103]
    ds_read_b64_tr_b16 v[252:253], v23 offset:8192
    v_mfma_f32_16x16x32_bf16 v[104:107], v[184:187], v[224:227], v[104:107]
    ds_read_b64_tr_b16 v[254:255], v23 offset:9216
    s_waitcnt lgkmcnt(11)
    v_mfma_f32_16x16x32_bf16 v[108:111], v[176:179], v[228:231], v[108:111]
    v_mfma_f32_16x16x32_bf16 v[112:115], v[180:183], v[228:231], v[112:115]
    v_mfma_f32_16x16x32_bf16 v[116:119], v[184:187], v[228:231], v[116:119]
    v_mfma_f32_16x16x32_bf16 v[120:123], v[176:179], v[232:235], v[120:123]
    v_mfma_f32_16x16x32_bf16 v[124:127], v[180:183], v[232:235], v[124:127]
    v_mfma_f32_16x16x32_bf16 v[128:131], v[184:187], v[232:235], v[128:131]
    v_mfma_f32_16x16x32_bf16 v[132:135], v[176:179], v[236:239], v[132:135]
    v_mfma_f32_16x16x32_bf16 v[136:139], v[180:183], v[236:239], v[136:139]
    v_mfma_f32_16x16x32_bf16 v[140:143], v[184:187], v[236:239], v[140:143]
    s_waitcnt lgkmcnt(7)
    v_mfma_f32_16x16x32_bf16 v[72:75], v[24:27], v[200:203], 0
    v_mfma_f32_16x16x32_bf16 v[76:79], v[24:27], v[204:207], 0
    v_mfma_f32_16x16x32_bf16 v[80:83], v[24:27], v[208:211], 0
    v_mfma_f32_16x16x32_bf16 v[84:87], v[28:31], v[200:203], 0
    v_mfma_f32_16x16x32_bf16 v[88:91], v[28:31], v[204:207], 0
    s_waitcnt lgkmcnt(0)
    s_barrier
    v_mfma_f32_16x16x32_bf16 v[92:95], v[28:31], v[208:211], 0
    ds_read_b128 v[176:179], v8 offset:0
    v_mfma_f32_16x16x32_bf16 v[96:99], v[188:191], v[240:243], v[96:99]
    ds_read_b64_tr_b16 v[224:225], v20 offset:16384
    v_mfma_f32_16x16x32_bf16 v[100:103], v[192:195], v[240:243], v[100:103]
    ds_read_b64_tr_b16 v[226:227], v20 offset:17408
    v_mfma_f32_16x16x32_bf16 v[104:107], v[196:199], v[240:243], v[104:107]
    ds_read_b128 v[180:183], v8 offset:4096
    v_mfma_f32_16x16x32_bf16 v[108:111], v[188:191], v[244:247], v[108:111]
    ds_read_b128 v[184:187], v8 offset:8192
    s_nop 0
    v_cvt_pk_bf16_f32 v144, v96, v97
    v_mfma_f32_16x16x32_bf16 v[112:115], v[192:195], v[244:247], v[112:115]
    v_cvt_pk_bf16_f32 v145, v98, v99
    ds_read_b64_tr_b16 v[228:229], v21 offset:16384
    v_mfma_f32_16x16x32_bf16 v[116:119], v[196:199], v[244:247], v[116:119]
    ds_read_b64_tr_b16 v[230:231], v21 offset:17408
    v_cvt_pk_bf16_f32 v146, v100, v101
    v_mfma_f32_16x16x32_bf16 v[120:123], v[188:191], v[248:251], v[120:123]
    ds_read_b64_tr_b16 v[232:233], v22 offset:16384
    v_cvt_pk_bf16_f32 v148, v108, v109
    v_mfma_f32_16x16x32_bf16 v[124:127], v[192:195], v[248:251], v[124:127]
    ds_read_b64_tr_b16 v[234:235], v22 offset:17408
    v_cvt_pk_bf16_f32 v149, v110, v111
    v_mfma_f32_16x16x32_bf16 v[128:131], v[196:199], v[248:251], v[128:131]
    ds_read_b64_tr_b16 v[236:237], v23 offset:16384
    v_cvt_pk_bf16_f32 v147, v102, v103
    v_mfma_f32_16x16x32_bf16 v[132:135], v[188:191], v[252:255], v[132:135]
    ds_read_b64_tr_b16 v[238:239], v23 offset:17408
    v_cvt_pk_bf16_f32 v152, v120, v121
    v_mfma_f32_16x16x32_bf16 v[136:139], v[192:195], v[252:255], v[136:139]
    ds_read_b128 v[212:215], v5 offset:6144
    v_cvt_pk_bf16_f32 v153, v122, v123
    v_mfma_f32_16x16x32_bf16 v[140:143], v[196:199], v[252:255], v[140:143]
    v_cvt_pk_bf16_f32 v160, v104, v105
    ds_read_b128 v[216:219], v5 offset:7168
    s_waitcnt lgkmcnt(8)
    v_mfma_f32_16x16x32_bf16 v[96:99], v[176:179], v[224:227], 0
    v_cvt_pk_bf16_f32 v161, v106, v107
    v_cvt_pk_bf16_f32 v156, v132, v133
    v_mfma_f32_16x16x32_bf16 v[100:103], v[180:183], v[224:227], 0
    ds_read_b128 v[220:223], v5 offset:8192
    v_cvt_pk_bf16_f32 v157, v134, v135
    v_mfma_f32_16x16x32_bf16 v[104:107], v[184:187], v[224:227], 0
    v_cvt_pk_bf16_f32 v150, v112, v113
    ds_read_b128 v[200:203], v5 offset:12288
    s_waitcnt lgkmcnt(7)
    v_mfma_f32_16x16x32_bf16 v[108:111], v[176:179], v[228:231], 0
    v_cvt_pk_bf16_f32 v151, v114, v115
    v_cvt_pk_bf16_f32 v154, v124, v125
    v_mfma_f32_16x16x32_bf16 v[112:115], v[180:183], v[228:231], 0
    ds_read_b128 v[204:207], v5 offset:13312
    v_cvt_pk_bf16_f32 v155, v126, v127
    s_waitcnt lgkmcnt(5)
    v_mfma_f32_16x16x32_bf16 v[120:123], v[176:179], v[232:235], 0
    v_cvt_pk_bf16_f32 v158, v136, v137
    ds_read_b128 v[208:211], v5 offset:14336
    v_mfma_f32_16x16x32_bf16 v[124:127], v[180:183], v[232:235], 0
    v_cvt_pk_bf16_f32 v159, v138, v139
    v_cvt_pk_bf16_f32 v164, v116, v117
    v_mfma_f32_16x16x32_bf16 v[132:135], v[176:179], v[236:239], 0
    ds_read_b128 v[188:191], v9 offset:0
    v_cvt_pk_bf16_f32 v165, v118, v119
    v_mfma_f32_16x16x32_bf16 v[116:119], v[184:187], v[228:231], 0
    v_cvt_pk_bf16_f32 v168, v128, v129
    ds_read_b64_tr_b16 v[240:241], v20 offset:24576
    v_mfma_f32_16x16x32_bf16 v[136:139], v[180:183], v[236:239], 0
    ds_read_b64_tr_b16 v[242:243], v20 offset:25600
    v_cvt_pk_bf16_f32 v169, v130, v131
    v_mfma_f32_16x16x32_bf16 v[128:131], v[184:187], v[232:235], 0
    ds_read_b128 v[192:195], v9 offset:4096
    v_cvt_pk_bf16_f32 v172, v140, v141
    s_waitcnt lgkmcnt(6)
    v_mfma_f32_16x16x32_bf16 v[72:75], v[32:35], v[212:215], v[72:75]
    v_cvt_pk_bf16_f32 v173, v142, v143
    ds_read_b128 v[196:199], v9 offset:8192
    v_mfma_f32_16x16x32_bf16 v[140:143], v[184:187], v[236:239], 0
    ds_read_b64_tr_b16 v[244:245], v21 offset:24576
    v_mfma_f32_16x16x32_bf16 v[76:79], v[32:35], v[216:219], v[76:79]
    ds_read_b64_tr_b16 v[246:247], v21 offset:25600
    v_mfma_f32_16x16x32_bf16 v[80:83], v[32:35], v[220:223], v[80:83]
    ds_read_b64_tr_b16 v[248:249], v22 offset:24576
    v_mfma_f32_16x16x32_bf16 v[84:87], v[36:39], v[212:215], v[84:87]
    ds_read_b64_tr_b16 v[250:251], v22 offset:25600
    v_mfma_f32_16x16x32_bf16 v[88:91], v[36:39], v[216:219], v[88:91]
    ds_read_b64_tr_b16 v[252:253], v23 offset:24576
    v_mfma_f32_16x16x32_bf16 v[92:95], v[36:39], v[220:223], v[92:95]
    ds_read_b64_tr_b16 v[254:255], v23 offset:25600
    v_mfma_f32_16x16x32_bf16 v[72:75], v[40:43], v[200:203], v[72:75]
    ds_read_b128 v[176:179], v10 offset:0
    s_waitcnt lgkmcnt(10)
    v_mfma_f32_16x16x32_bf16 v[76:79], v[40:43], v[204:207], v[76:79]
    ds_read_b64_tr_b16 v[224:225], v16 offset:0
    v_mfma_f32_16x16x32_bf16 v[80:83], v[40:43], v[208:211], v[80:83]
    ds_read_b64_tr_b16 v[226:227], v16 offset:1024
    v_mfma_f32_16x16x32_bf16 v[84:87], v[44:47], v[200:203], v[84:87]
    ds_read_b128 v[180:183], v10 offset:4096
    v_cvt_pk_bf16_f32 v72, v72, v73
    v_mfma_f32_16x16x32_bf16 v[88:91], v[44:47], v[204:207], v[88:91]
    v_cvt_pk_bf16_f32 v73, v74, v75
    ds_read_b128 v[184:187], v10 offset:8192
    v_mfma_f32_16x16x32_bf16 v[92:95], v[44:47], v[208:211], v[92:95]
    v_cvt_pk_bf16_f32 v76, v76, v77
    v_cvt_pk_bf16_f32 v80, v80, v81
    s_waitcnt lgkmcnt(9)
    v_mfma_f32_16x16x32_bf16 v[96:99], v[188:191], v[240:243], v[96:99]
    ds_read_b64_tr_b16 v[228:229], v17 offset:0
    v_cvt_pk_bf16_f32 v77, v78, v79
    v_mfma_f32_16x16x32_bf16 v[100:103], v[192:195], v[240:243], v[100:103]
    ds_read_b64_tr_b16 v[230:231], v17 offset:1024
    v_cvt_pk_bf16_f32 v74, v84, v85
    v_mfma_f32_16x16x32_bf16 v[104:107], v[196:199], v[240:243], v[104:107]
    ds_read_b64_tr_b16 v[232:233], v18 offset:0
    v_cvt_pk_bf16_f32 v75, v86, v87
    v_mfma_f32_16x16x32_bf16 v[108:111], v[188:191], v[244:247], v[108:111]
    ds_read_b64_tr_b16 v[234:235], v18 offset:1024
    v_cvt_pk_bf16_f32 v81, v82, v83
    v_mfma_f32_16x16x32_bf16 v[112:115], v[192:195], v[244:247], v[112:115]
    ds_read_b64_tr_b16 v[236:237], v19 offset:0
    v_cvt_pk_bf16_f32 v78, v88, v89
    v_mfma_f32_16x16x32_bf16 v[116:119], v[196:199], v[244:247], v[116:119]
    ds_read_b64_tr_b16 v[238:239], v19 offset:1024
    v_cvt_pk_bf16_f32 v79, v90, v91
    s_waitcnt lgkmcnt(7)
    v_mfma_f32_16x16x32_bf16 v[120:123], v[188:191], v[248:251], v[120:123]
    ds_read_b128 v[212:215], v5 offset:0
    v_cvt_pk_bf16_f32 v82, v92, v93
    v_mfma_f32_16x16x32_bf16 v[124:127], v[192:195], v[248:251], v[124:127]
    v_cvt_pk_bf16_f32 v83, v94, v95
    ds_read_b128 v[216:219], v5 offset:1024
    v_mfma_f32_16x16x32_bf16 v[128:131], v[196:199], v[248:251], v[128:131]
    ds_read_b128 v[220:223], v5 offset:2048
    v_mfma_f32_16x16x32_bf16 v[132:135], v[188:191], v[252:255], v[132:135]
    v_mfma_f32_16x16x32_bf16 v[136:139], v[192:195], v[252:255], v[136:139]
    ds_read_b128 v[188:191], v11 offset:0
    v_mfma_f32_16x16x32_bf16 v[140:143], v[196:199], v[252:255], v[140:143]
    ds_read_b64_tr_b16 v[240:241], v16 offset:8192
    v_mfma_f32_16x16x32_bf16 v[96:99], v[176:179], v[224:227], v[96:99]
    ds_read_b64_tr_b16 v[242:243], v16 offset:9216
    v_mfma_f32_16x16x32_bf16 v[100:103], v[180:183], v[224:227], v[100:103]
    ds_read_b128 v[192:195], v11 offset:4096
    s_waitcnt lgkmcnt(9)
    v_mfma_f32_16x16x32_bf16 v[104:107], v[184:187], v[224:227], v[104:107]
    ds_read_b128 v[196:199], v11 offset:8192
    v_mfma_f32_16x16x32_bf16 v[108:111], v[176:179], v[228:231], v[108:111]
    ds_read_b64_tr_b16 v[244:245], v17 offset:8192
    v_mfma_f32_16x16x32_bf16 v[112:115], v[180:183], v[228:231], v[112:115]
    ds_read_b64_tr_b16 v[246:247], v17 offset:9216
    v_mfma_f32_16x16x32_bf16 v[116:119], v[184:187], v[228:231], v[116:119]
    ds_read_b64_tr_b16 v[248:249], v18 offset:8192
    v_mfma_f32_16x16x32_bf16 v[120:123], v[176:179], v[232:235], v[120:123]
    ds_read_b64_tr_b16 v[250:251], v18 offset:9216
    v_mfma_f32_16x16x32_bf16 v[124:127], v[180:183], v[232:235], v[124:127]
    ds_read_b64_tr_b16 v[252:253], v19 offset:8192
    v_mfma_f32_16x16x32_bf16 v[128:131], v[184:187], v[232:235], v[128:131]
    ds_read_b64_tr_b16 v[254:255], v19 offset:9216
    buffer_store_dwordx4 v[72:75], v6, s[40:43], s74 offen offset:0 sc1
    s_waitcnt lgkmcnt(11)
    v_mfma_f32_16x16x32_bf16 v[132:135], v[176:179], v[236:239], v[132:135]
    buffer_store_dwordx4 v[76:79], v6, s[40:43], s74 offen offset:1024 sc1
    buffer_store_dwordx4 v[80:83], v6, s[40:43], s74 offen offset:2048 sc1
    v_mfma_f32_16x16x32_bf16 v[136:139], v[180:183], v[236:239], v[136:139]
    buffer_load_dwordx2 v[84:85], v7, s[48:51], 0 offen sc1
    v_mfma_f32_16x16x32_bf16 v[140:143], v[184:187], v[236:239], v[140:143]
    v_mfma_f32_16x16x32_bf16 v[24:27], v[144:147], v[212:215], 0
    v_mfma_f32_16x16x32_bf16 v[28:31], v[144:147], v[216:219], 0
    v_mfma_f32_16x16x32_bf16 v[32:35], v[144:147], v[220:223], 0
    v_mfma_f32_16x16x32_bf16 v[36:39], v[148:151], v[212:215], 0
    v_mfma_f32_16x16x32_bf16 v[40:43], v[148:151], v[216:219], 0
    s_waitcnt lgkmcnt(0)
    s_barrier
    v_mfma_f32_16x16x32_bf16 v[44:47], v[148:151], v[220:223], 0
    ds_read_b128 v[176:179], v12 offset:0
    v_mfma_f32_16x16x32_bf16 v[48:51], v[152:155], v[212:215], 0
    ds_read_b64_tr_b16 v[224:225], v16 offset:20480
    v_mfma_f32_16x16x32_bf16 v[52:55], v[152:155], v[216:219], 0
    ds_read_b64_tr_b16 v[226:227], v16 offset:21504
    v_mfma_f32_16x16x32_bf16 v[56:59], v[152:155], v[220:223], 0
    ds_read_b128 v[180:183], v12 offset:4096
    v_mfma_f32_16x16x32_bf16 v[60:63], v[156:159], v[212:215], 0
    ds_read_b128 v[184:187], v12 offset:8192
    v_mfma_f32_16x16x32_bf16 v[64:67], v[156:159], v[216:219], 0
    ds_read_b64_tr_b16 v[228:229], v17 offset:20480
    v_mfma_f32_16x16x32_bf16 v[68:71], v[156:159], v[220:223], 0
    ds_read_b64_tr_b16 v[230:231], v17 offset:21504
    v_mfma_f32_16x16x32_bf16 v[96:99], v[188:191], v[240:243], v[96:99]
    ds_read_b64_tr_b16 v[232:233], v18 offset:20480
    v_mfma_f32_16x16x32_bf16 v[100:103], v[192:195], v[240:243], v[100:103]
    ds_read_b64_tr_b16 v[234:235], v18 offset:21504
    v_mfma_f32_16x16x32_bf16 v[104:107], v[196:199], v[240:243], v[104:107]
    ds_read_b64_tr_b16 v[236:237], v19 offset:20480
    v_mfma_f32_16x16x32_bf16 v[108:111], v[188:191], v[244:247], v[108:111]
    ds_read_b64_tr_b16 v[238:239], v19 offset:21504
    s_nop 0
    v_cvt_pk_bf16_f32 v144, v96, v97
    v_mfma_f32_16x16x32_bf16 v[112:115], v[192:195], v[244:247], v[112:115]
    ds_read_b128 v[200:203], v5 offset:6144
    v_cvt_pk_bf16_f32 v145, v98, v99
    v_mfma_f32_16x16x32_bf16 v[116:119], v[196:199], v[244:247], v[116:119]
    v_cvt_pk_bf16_f32 v146, v100, v101
    ds_read_b128 v[204:207], v5 offset:7168
    v_mfma_f32_16x16x32_bf16 v[120:123], v[188:191], v[248:251], v[120:123]
    v_cvt_pk_bf16_f32 v147, v102, v103
    v_cvt_pk_bf16_f32 v148, v108, v109
    v_mfma_f32_16x16x32_bf16 v[124:127], v[192:195], v[248:251], v[124:127]
    ds_read_b128 v[208:211], v5 offset:8192
    v_cvt_pk_bf16_f32 v149, v110, v111
    v_mfma_f32_16x16x32_bf16 v[128:131], v[196:199], v[248:251], v[128:131]
    v_cvt_pk_bf16_f32 v162, v104, v105
    v_cvt_pk_bf16_f32 v163, v106, v107
    v_mfma_f32_16x16x32_bf16 v[132:135], v[188:191], v[252:255], v[132:135]
    v_cvt_pk_bf16_f32 v150, v112, v113
    ds_read_b128 v[188:191], v13 offset:0
    v_mfma_f32_16x16x32_bf16 v[136:139], v[192:195], v[252:255], v[136:139]
    v_cvt_pk_bf16_f32 v152, v120, v121
    v_cvt_pk_bf16_f32 v153, v122, v123
    v_mfma_f32_16x16x32_bf16 v[140:143], v[196:199], v[252:255], v[140:143]
    ds_read_b64_tr_b16 v[240:241], v16 offset:28672
    v_cvt_pk_bf16_f32 v151, v114, v115
    s_waitcnt lgkmcnt(5)
    v_mfma_f32_16x16x32_bf16 v[96:99], v[176:179], v[224:227], 0
    ds_read_b64_tr_b16 v[242:243], v16 offset:29696
    v_cvt_pk_bf16_f32 v156, v132, v133
    v_mfma_f32_16x16x32_bf16 v[100:103], v[180:183], v[224:227], 0
    ds_read_b128 v[192:195], v13 offset:4096
    v_cvt_pk_bf16_f32 v157, v134, v135
    v_mfma_f32_16x16x32_bf16 v[104:107], v[184:187], v[224:227], 0
    v_cvt_pk_bf16_f32 v154, v124, v125
    ds_read_b128 v[196:199], v13 offset:8192
    v_mfma_f32_16x16x32_bf16 v[108:111], v[176:179], v[228:231], 0
    v_cvt_pk_bf16_f32 v155, v126, v127
    v_cvt_pk_bf16_f32 v158, v136, v137
    v_mfma_f32_16x16x32_bf16 v[112:115], v[180:183], v[228:231], 0
    ds_read_b64_tr_b16 v[244:245], v17 offset:28672
    v_cvt_pk_bf16_f32 v159, v138, v139
    v_mfma_f32_16x16x32_bf16 v[120:123], v[176:179], v[232:235], 0
    ds_read_b64_tr_b16 v[246:247], v17 offset:29696
    v_cvt_pk_bf16_f32 v166, v116, v117
    v_mfma_f32_16x16x32_bf16 v[124:127], v[180:183], v[232:235], 0
    ds_read_b64_tr_b16 v[248:249], v18 offset:28672
    v_cvt_pk_bf16_f32 v167, v118, v119
    v_mfma_f32_16x16x32_bf16 v[116:119], v[184:187], v[228:231], 0
    v_cvt_pk_bf16_f32 v170, v128, v129
    v_cvt_pk_bf16_f32 v171, v130, v131
    v_mfma_f32_16x16x32_bf16 v[128:131], v[184:187], v[232:235], 0
    v_cvt_pk_bf16_f32 v174, v140, v141
    v_cvt_pk_bf16_f32 v175, v142, v143
    v_mfma_f32_16x16x32_bf16 v[132:135], v[176:179], v[236:239], 0
    ds_read_b64_tr_b16 v[250:251], v18 offset:29696
    v_mfma_f32_16x16x32_bf16 v[136:139], v[180:183], v[236:239], 0
    ds_read_b64_tr_b16 v[252:253], v19 offset:28672
    v_mfma_f32_16x16x32_bf16 v[140:143], v[184:187], v[236:239], 0
    ds_read_b64_tr_b16 v[254:255], v19 offset:29696
    s_waitcnt lgkmcnt(6)
    v_mfma_f32_16x16x32_bf16 v[24:27], v[144:147], v[200:203], v[24:27]
    ds_read_b128 v[176:179], v14 offset:0
    v_mfma_f32_16x16x32_bf16 v[28:31], v[144:147], v[204:207], v[28:31]
    ds_read_b64_tr_b16 v[224:225], v16 offset:36864
    v_mfma_f32_16x16x32_bf16 v[32:35], v[144:147], v[208:211], v[32:35]
    ds_read_b64_tr_b16 v[226:227], v16 offset:37888
    v_mfma_f32_16x16x32_bf16 v[36:39], v[148:151], v[200:203], v[36:39]
    ds_read_b128 v[180:183], v14 offset:4096
    v_mfma_f32_16x16x32_bf16 v[40:43], v[148:151], v[204:207], v[40:43]
    ds_read_b128 v[184:187], v14 offset:8192
    v_mfma_f32_16x16x32_bf16 v[44:47], v[148:151], v[208:211], v[44:47]
    ds_read_b64_tr_b16 v[228:229], v17 offset:36864
    v_mfma_f32_16x16x32_bf16 v[48:51], v[152:155], v[200:203], v[48:51]
    ds_read_b64_tr_b16 v[230:231], v17 offset:37888
    v_mfma_f32_16x16x32_bf16 v[52:55], v[152:155], v[204:207], v[52:55]
    ds_read_b64_tr_b16 v[232:233], v18 offset:36864
    v_mfma_f32_16x16x32_bf16 v[56:59], v[152:155], v[208:211], v[56:59]
    ds_read_b64_tr_b16 v[234:235], v18 offset:37888
    v_mfma_f32_16x16x32_bf16 v[60:63], v[156:159], v[200:203], v[60:63]
    ds_read_b64_tr_b16 v[236:237], v19 offset:36864
    v_mfma_f32_16x16x32_bf16 v[64:67], v[156:159], v[204:207], v[64:67]
    ds_read_b64_tr_b16 v[238:239], v19 offset:37888
    v_mfma_f32_16x16x32_bf16 v[68:71], v[156:159], v[208:211], v[68:71]
    ds_read_b128 v[212:215], v5 offset:12288
    v_mfma_f32_16x16x32_bf16 v[96:99], v[188:191], v[240:243], v[96:99]
    ds_read_b128 v[216:219], v5 offset:13312
    v_mfma_f32_16x16x32_bf16 v[100:103], v[192:195], v[240:243], v[100:103]
    ds_read_b128 v[220:223], v5 offset:14336
    v_mfma_f32_16x16x32_bf16 v[104:107], v[196:199], v[240:243], v[104:107]
    s_waitcnt lgkmcnt(12)
    v_mfma_f32_16x16x32_bf16 v[108:111], v[188:191], v[244:247], v[108:111]
    v_mfma_f32_16x16x32_bf16 v[112:115], v[192:195], v[244:247], v[112:115]
    v_mfma_f32_16x16x32_bf16 v[116:119], v[196:199], v[244:247], v[116:119]
    v_mfma_f32_16x16x32_bf16 v[120:123], v[188:191], v[248:251], v[120:123]
    v_mfma_f32_16x16x32_bf16 v[124:127], v[192:195], v[248:251], v[124:127]
    v_mfma_f32_16x16x32_bf16 v[128:131], v[196:199], v[248:251], v[128:131]
    v_mfma_f32_16x16x32_bf16 v[132:135], v[188:191], v[252:255], v[132:135]
    ds_read_b128 v[188:191], v15 offset:0
    v_mfma_f32_16x16x32_bf16 v[136:139], v[192:195], v[252:255], v[136:139]
    ds_read_b64_tr_b16 v[240:241], v16 offset:45056
    v_mfma_f32_16x16x32_bf16 v[140:143], v[196:199], v[252:255], v[140:143]
    ds_read_b64_tr_b16 v[242:243], v16 offset:46080
    s_waitcnt lgkmcnt(8)
    v_mfma_f32_16x16x32_bf16 v[96:99], v[176:179], v[224:227], v[96:99]
    ds_read_b128 v[192:195], v15 offset:4096
    v_mfma_f32_16x16x32_bf16 v[100:103], v[180:183], v[224:227], v[100:103]
    ds_read_b128 v[196:199], v15 offset:8192
    v_mfma_f32_16x16x32_bf16 v[104:107], v[184:187], v[224:227], v[104:107]
    ds_read_b64_tr_b16 v[244:245], v17 offset:45056
    v_mfma_f32_16x16x32_bf16 v[108:111], v[176:179], v[228:231], v[108:111]
    ds_read_b64_tr_b16 v[246:247], v17 offset:46080
    v_mfma_f32_16x16x32_bf16 v[112:115], v[180:183], v[228:231], v[112:115]
    ds_read_b64_tr_b16 v[248:249], v18 offset:45056
    v_mfma_f32_16x16x32_bf16 v[116:119], v[184:187], v[228:231], v[116:119]
    ds_read_b64_tr_b16 v[250:251], v18 offset:46080
    v_mfma_f32_16x16x32_bf16 v[120:123], v[176:179], v[232:235], v[120:123]
    ds_read_b64_tr_b16 v[252:253], v19 offset:45056
    v_mfma_f32_16x16x32_bf16 v[124:127], v[180:183], v[232:235], v[124:127]
    ds_read_b64_tr_b16 v[254:255], v19 offset:46080
    v_mfma_f32_16x16x32_bf16 v[128:131], v[184:187], v[232:235], v[128:131]
    s_waitcnt lgkmcnt(11)
    v_mfma_f32_16x16x32_bf16 v[132:135], v[176:179], v[236:239], v[132:135]
    v_mfma_f32_16x16x32_bf16 v[136:139], v[180:183], v[236:239], v[136:139]
    v_mfma_f32_16x16x32_bf16 v[140:143], v[184:187], v[236:239], v[140:143]
    v_mfma_f32_16x16x32_bf16 v[24:27], v[160:163], v[212:215], v[24:27]
    v_mfma_f32_16x16x32_bf16 v[28:31], v[160:163], v[216:219], v[28:31]
    v_mfma_f32_16x16x32_bf16 v[32:35], v[160:163], v[220:223], v[32:35]
    v_mfma_f32_16x16x32_bf16 v[36:39], v[164:167], v[212:215], v[36:39]
    v_mfma_f32_16x16x32_bf16 v[40:43], v[164:167], v[216:219], v[40:43]
    s_waitcnt lgkmcnt(0)
    s_barrier
    v_mfma_f32_16x16x32_bf16 v[44:47], v[164:167], v[220:223], v[44:47]
    ds_read_b128 v[176:179], v12 offset:0
    v_mfma_f32_16x16x32_bf16 v[48:51], v[168:171], v[212:215], v[48:51]
    ds_read_b64_tr_b16 v[224:225], v20 offset:0
    v_mfma_f32_16x16x32_bf16 v[52:55], v[168:171], v[216:219], v[52:55]
    ds_read_b64_tr_b16 v[226:227], v20 offset:1024
    v_mfma_f32_16x16x32_bf16 v[56:59], v[168:171], v[220:223], v[56:59]
    ds_read_b128 v[180:183], v12 offset:4096
    v_mfma_f32_16x16x32_bf16 v[60:63], v[172:175], v[212:215], v[60:63]
    ds_read_b128 v[184:187], v12 offset:8192
    v_mfma_f32_16x16x32_bf16 v[64:67], v[172:175], v[216:219], v[64:67]
    ds_read_b64_tr_b16 v[228:229], v21 offset:0
    v_mfma_f32_16x16x32_bf16 v[68:71], v[172:175], v[220:223], v[68:71]
    ds_read_b64_tr_b16 v[230:231], v21 offset:1024
    v_mfma_f32_16x16x32_bf16 v[96:99], v[188:191], v[240:243], v[96:99]
    ds_read_b64_tr_b16 v[232:233], v22 offset:0
    v_mfma_f32_16x16x32_bf16 v[100:103], v[192:195], v[240:243], v[100:103]
    ds_read_b64_tr_b16 v[234:235], v22 offset:1024
    v_mfma_f32_16x16x32_bf16 v[104:107], v[196:199], v[240:243], v[104:107]
    ds_read_b64_tr_b16 v[236:237], v23 offset:0
    v_mfma_f32_16x16x32_bf16 v[108:111], v[188:191], v[244:247], v[108:111]
    ds_read_b64_tr_b16 v[238:239], v23 offset:1024
    s_nop 0
    v_cvt_pk_bf16_f32 v144, v96, v97
    v_mfma_f32_16x16x32_bf16 v[112:115], v[192:195], v[244:247], v[112:115]
    v_cvt_pk_bf16_f32 v145, v98, v99
    v_cvt_pk_bf16_f32 v146, v100, v101
    v_mfma_f32_16x16x32_bf16 v[116:119], v[196:199], v[244:247], v[116:119]
    v_cvt_pk_bf16_f32 v147, v102, v103
    v_cvt_pk_bf16_f32 v160, v104, v105
    v_mfma_f32_16x16x32_bf16 v[120:123], v[188:191], v[248:251], v[120:123]
    v_cvt_pk_bf16_f32 v161, v106, v107
    v_cvt_pk_bf16_f32 v148, v108, v109
    v_mfma_f32_16x16x32_bf16 v[124:127], v[192:195], v[248:251], v[124:127]
    v_cvt_pk_bf16_f32 v149, v110, v111
    v_cvt_pk_bf16_f32 v150, v112, v113
    v_mfma_f32_16x16x32_bf16 v[128:131], v[196:199], v[248:251], v[128:131]
    v_cvt_pk_bf16_f32 v151, v114, v115
    v_cvt_pk_bf16_f32 v164, v116, v117
    v_mfma_f32_16x16x32_bf16 v[132:135], v[188:191], v[252:255], v[132:135]
    v_cvt_pk_bf16_f32 v165, v118, v119
    ds_read_b128 v[188:191], v13 offset:0
    v_mfma_f32_16x16x32_bf16 v[136:139], v[192:195], v[252:255], v[136:139]
    v_cvt_pk_bf16_f32 v152, v120, v121
    v_cvt_pk_bf16_f32 v153, v122, v123
    v_mfma_f32_16x16x32_bf16 v[140:143], v[196:199], v[252:255], v[140:143]
    ds_read_b64_tr_b16 v[240:241], v20 offset:8192
    v_cvt_pk_bf16_f32 v154, v124, v125
    s_waitcnt lgkmcnt(2)
    v_mfma_f32_16x16x32_bf16 v[96:99], v[176:179], v[224:227], 0
    ds_read_b64_tr_b16 v[242:243], v20 offset:9216
    v_cvt_pk_bf16_f32 v156, v132, v133
    v_mfma_f32_16x16x32_bf16 v[100:103], v[180:183], v[224:227], 0
    ds_read_b128 v[192:195], v13 offset:4096
    v_cvt_pk_bf16_f32 v157, v134, v135
    v_mfma_f32_16x16x32_bf16 v[104:107], v[184:187], v[224:227], 0
    v_cvt_pk_bf16_f32 v155, v126, v127
    ds_read_b128 v[196:199], v13 offset:8192
    v_mfma_f32_16x16x32_bf16 v[108:111], v[176:179], v[228:231], 0
    v_cvt_pk_bf16_f32 v158, v136, v137
    v_cvt_pk_bf16_f32 v159, v138, v139
    v_mfma_f32_16x16x32_bf16 v[112:115], v[180:183], v[228:231], 0
    ds_read_b64_tr_b16 v[244:245], v21 offset:8192
    v_cvt_pk_bf16_f32 v168, v128, v129
    v_mfma_f32_16x16x32_bf16 v[116:119], v[184:187], v[228:231], 0
    ds_read_b64_tr_b16 v[246:247], v21 offset:9216
    v_cvt_pk_bf16_f32 v169, v130, v131
    v_mfma_f32_16x16x32_bf16 v[120:123], v[176:179], v[232:235], 0
    ds_read_b64_tr_b16 v[248:249], v22 offset:8192
    v_cvt_pk_bf16_f32 v172, v140, v141
    v_mfma_f32_16x16x32_bf16 v[124:127], v[180:183], v[232:235], 0
    v_cvt_pk_bf16_f32 v173, v142, v143
    ds_read_b64_tr_b16 v[250:251], v22 offset:9216
    v_mfma_f32_16x16x32_bf16 v[128:131], v[184:187], v[232:235], 0
    ds_read_b64_tr_b16 v[252:253], v23 offset:8192
    v_mfma_f32_16x16x32_bf16 v[132:135], v[176:179], v[236:239], 0
    ds_read_b64_tr_b16 v[254:255], v23 offset:9216
    v_mfma_f32_16x16x32_bf16 v[136:139], v[180:183], v[236:239], 0
    ds_read_b128 v[176:179], v14 offset:0
    v_mfma_f32_16x16x32_bf16 v[140:143], v[184:187], v[236:239], 0
    ds_read_b64_tr_b16 v[224:225], v20 offset:16384
    s_waitcnt lgkmcnt(9)
    v_mfma_f32_16x16x32_bf16 v[96:99], v[188:191], v[240:243], v[96:99]
    ds_read_b64_tr_b16 v[226:227], v20 offset:17408
    v_mfma_f32_16x16x32_bf16 v[100:103], v[192:195], v[240:243], v[100:103]
    ds_read_b128 v[180:183], v14 offset:4096
    s_waitcnt lgkmcnt(10)
    v_mfma_f32_16x16x32_bf16 v[104:107], v[196:199], v[240:243], v[104:107]
    ds_read_b128 v[184:187], v14 offset:8192
    s_waitcnt lgkmcnt(9)
    v_mfma_f32_16x16x32_bf16 v[108:111], v[188:191], v[244:247], v[108:111]
    ds_read_b64_tr_b16 v[228:229], v21 offset:16384
    v_mfma_f32_16x16x32_bf16 v[112:115], v[192:195], v[244:247], v[112:115]
    ds_read_b64_tr_b16 v[230:231], v21 offset:17408
    v_mfma_f32_16x16x32_bf16 v[116:119], v[196:199], v[244:247], v[116:119]
    ds_read_b64_tr_b16 v[232:233], v22 offset:16384
    s_waitcnt lgkmcnt(10)
    v_mfma_f32_16x16x32_bf16 v[120:123], v[188:191], v[248:251], v[120:123]
    ds_read_b64_tr_b16 v[234:235], v22 offset:17408
    v_mfma_f32_16x16x32_bf16 v[124:127], v[192:195], v[248:251], v[124:127]
    ds_read_b64_tr_b16 v[236:237], v23 offset:16384
    v_mfma_f32_16x16x32_bf16 v[128:131], v[196:199], v[248:251], v[128:131]
    ds_read_b64_tr_b16 v[238:239], v23 offset:17408
    s_waitcnt lgkmcnt(10)
    v_mfma_f32_16x16x32_bf16 v[132:135], v[188:191], v[252:255], v[132:135]
    ds_read_b128 v[212:215], v5 offset:0
    v_mfma_f32_16x16x32_bf16 v[136:139], v[192:195], v[252:255], v[136:139]
    ds_read_b128 v[216:219], v5 offset:1024
    v_mfma_f32_16x16x32_bf16 v[140:143], v[196:199], v[252:255], v[140:143]
    ds_read_b128 v[220:223], v5 offset:2048
    s_waitcnt lgkmcnt(10)
    v_mfma_f32_16x16x32_bf16 v[96:99], v[176:179], v[224:227], v[96:99]
    ds_read_b128 v[188:191], v15 offset:0
    v_mfma_f32_16x16x32_bf16 v[100:103], v[180:183], v[224:227], v[100:103]
    s_waitcnt lgkmcnt(10)
    v_mfma_f32_16x16x32_bf16 v[104:107], v[184:187], v[224:227], v[104:107]
    ds_read_b64_tr_b16 v[240:241], v20 offset:24576
    s_waitcnt lgkmcnt(9)
    v_mfma_f32_16x16x32_bf16 v[108:111], v[176:179], v[228:231], v[108:111]
    ds_read_b64_tr_b16 v[242:243], v20 offset:25600
    v_mfma_f32_16x16x32_bf16 v[112:115], v[180:183], v[228:231], v[112:115]
    ds_read_b128 v[192:195], v15 offset:4096
    v_mfma_f32_16x16x32_bf16 v[116:119], v[184:187], v[228:231], v[116:119]
    ds_read_b128 v[196:199], v15 offset:8192
    s_waitcnt lgkmcnt(10)
    v_mfma_f32_16x16x32_bf16 v[120:123], v[176:179], v[232:235], v[120:123]
    ds_read_b64_tr_b16 v[244:245], v21 offset:24576
    v_mfma_f32_16x16x32_bf16 v[124:127], v[180:183], v[232:235], v[124:127]
    ds_read_b64_tr_b16 v[246:247], v21 offset:25600
    v_mfma_f32_16x16x32_bf16 v[128:131], v[184:187], v[232:235], v[128:131]
    ds_read_b64_tr_b16 v[248:249], v22 offset:24576
    s_waitcnt lgkmcnt(10)
    v_mfma_f32_16x16x32_bf16 v[132:135], v[176:179], v[236:239], v[132:135]
    ds_read_b64_tr_b16 v[250:251], v22 offset:25600
    v_mfma_f32_16x16x32_bf16 v[140:143], v[184:187], v[236:239], v[140:143]
    ds_read_b64_tr_b16 v[252:253], v23 offset:24576
    v_mfma_f32_16x16x32_bf16 v[24:27], v[144:147], v[212:215], v[24:27]
    ds_read_b64_tr_b16 v[254:255], v23 offset:25600
    s_waitcnt vmcnt(0)
    v_mfma_f32_16x16x32_bf16 v[136:139], v[180:183], v[236:239], v[136:139]
    buffer_store_dwordx2 v[84:85], v7, s[40:43], s75 offen sc1
    v_readfirstlane_b32 s66, v84
    s_waitcnt lgkmcnt(9)
    v_mfma_f32_16x16x32_bf16 v[28:31], v[144:147], v[216:219], v[28:31]
    v_readfirstlane_b32 s67, v85
    v_mfma_f32_16x16x32_bf16 v[32:35], v[144:147], v[220:223], v[32:35]
    v_mfma_f32_16x16x32_bf16 v[36:39], v[148:151], v[212:215], v[36:39]
    v_mfma_f32_16x16x32_bf16 v[40:43], v[148:151], v[216:219], v[40:43]
    s_waitcnt lgkmcnt(0)
    s_barrier
    v_mfma_f32_16x16x32_bf16 v[44:47], v[148:151], v[220:223], v[44:47]
    ds_read_b128 v[176:179], v8 offset:0
    v_mfma_f32_16x16x32_bf16 v[48:51], v[152:155], v[212:215], v[48:51]
    ds_read_b64_tr_b16 v[224:225], v16 offset:0
    v_mfma_f32_16x16x32_bf16 v[52:55], v[152:155], v[216:219], v[52:55]
    ds_read_b64_tr_b16 v[226:227], v16 offset:1024
    v_mfma_f32_16x16x32_bf16 v[56:59], v[152:155], v[220:223], v[56:59]
    ds_read_b128 v[180:183], v8 offset:4096
    v_mfma_f32_16x16x32_bf16 v[60:63], v[156:159], v[212:215], v[60:63]
    ds_read_b128 v[184:187], v8 offset:8192
    v_mfma_f32_16x16x32_bf16 v[64:67], v[156:159], v[216:219], v[64:67]
    ds_read_b64_tr_b16 v[228:229], v17 offset:0
    v_mfma_f32_16x16x32_bf16 v[68:71], v[156:159], v[220:223], v[68:71]
    ds_read_b64_tr_b16 v[230:231], v17 offset:1024
    v_mfma_f32_16x16x32_bf16 v[96:99], v[188:191], v[240:243], v[96:99]
    ds_read_b64_tr_b16 v[232:233], v18 offset:0
    v_mfma_f32_16x16x32_bf16 v[100:103], v[192:195], v[240:243], v[100:103]
    ds_read_b64_tr_b16 v[234:235], v18 offset:1024
    v_mfma_f32_16x16x32_bf16 v[104:107], v[196:199], v[240:243], v[104:107]
    ds_read_b64_tr_b16 v[236:237], v19 offset:0
    v_mfma_f32_16x16x32_bf16 v[108:111], v[188:191], v[244:247], v[108:111]
    ds_read_b64_tr_b16 v[238:239], v19 offset:1024
    s_nop 0
    v_cvt_pk_bf16_f32 v144, v96, v97
    v_mfma_f32_16x16x32_bf16 v[112:115], v[192:195], v[244:247], v[112:115]
    ds_read_b128 v[200:203], v5 offset:6144
    v_cvt_pk_bf16_f32 v145, v98, v99
    v_mfma_f32_16x16x32_bf16 v[116:119], v[196:199], v[244:247], v[116:119]
    v_cvt_pk_bf16_f32 v146, v100, v101
    ds_read_b128 v[204:207], v5 offset:7168
    v_mfma_f32_16x16x32_bf16 v[120:123], v[188:191], v[248:251], v[120:123]
    v_cvt_pk_bf16_f32 v147, v102, v103
    v_cvt_pk_bf16_f32 v148, v108, v109
    v_mfma_f32_16x16x32_bf16 v[124:127], v[192:195], v[248:251], v[124:127]
    ds_read_b128 v[208:211], v5 offset:8192
    v_cvt_pk_bf16_f32 v149, v110, v111
    v_mfma_f32_16x16x32_bf16 v[128:131], v[196:199], v[248:251], v[128:131]
    v_cvt_pk_bf16_f32 v162, v104, v105
    v_cvt_pk_bf16_f32 v163, v106, v107
    v_mfma_f32_16x16x32_bf16 v[132:135], v[188:191], v[252:255], v[132:135]
    v_cvt_pk_bf16_f32 v150, v112, v113
    ds_read_b128 v[188:191], v9 offset:0
    v_mfma_f32_16x16x32_bf16 v[136:139], v[192:195], v[252:255], v[136:139]
    v_cvt_pk_bf16_f32 v152, v120, v121
    v_cvt_pk_bf16_f32 v153, v122, v123
    v_mfma_f32_16x16x32_bf16 v[140:143], v[196:199], v[252:255], v[140:143]
    ds_read_b64_tr_b16 v[240:241], v16 offset:8192
    v_cvt_pk_bf16_f32 v151, v114, v115
    s_waitcnt lgkmcnt(5)
    v_mfma_f32_16x16x32_bf16 v[96:99], v[176:179], v[224:227], 0
    ds_read_b64_tr_b16 v[242:243], v16 offset:9216
    v_cvt_pk_bf16_f32 v156, v132, v133
    v_mfma_f32_16x16x32_bf16 v[100:103], v[180:183], v[224:227], 0
    ds_read_b128 v[192:195], v9 offset:4096
    v_cvt_pk_bf16_f32 v157, v134, v135
    v_mfma_f32_16x16x32_bf16 v[104:107], v[184:187], v[224:227], 0
    v_cvt_pk_bf16_f32 v154, v124, v125
    ds_read_b128 v[196:199], v9 offset:8192
    v_mfma_f32_16x16x32_bf16 v[108:111], v[176:179], v[228:231], 0
    v_cvt_pk_bf16_f32 v155, v126, v127
    v_cvt_pk_bf16_f32 v158, v136, v137
    v_mfma_f32_16x16x32_bf16 v[112:115], v[180:183], v[228:231], 0
    ds_read_b64_tr_b16 v[244:245], v17 offset:8192
    v_cvt_pk_bf16_f32 v159, v138, v139
    v_mfma_f32_16x16x32_bf16 v[120:123], v[176:179], v[232:235], 0
    ds_read_b64_tr_b16 v[246:247], v17 offset:9216
    v_cvt_pk_bf16_f32 v166, v116, v117
    v_mfma_f32_16x16x32_bf16 v[124:127], v[180:183], v[232:235], 0
    ds_read_b64_tr_b16 v[248:249], v18 offset:8192
    v_cvt_pk_bf16_f32 v167, v118, v119
    v_mfma_f32_16x16x32_bf16 v[116:119], v[184:187], v[228:231], 0
    v_cvt_pk_bf16_f32 v170, v128, v129
    v_cvt_pk_bf16_f32 v171, v130, v131
    v_mfma_f32_16x16x32_bf16 v[128:131], v[184:187], v[232:235], 0
    v_cvt_pk_bf16_f32 v174, v140, v141
    v_cvt_pk_bf16_f32 v175, v142, v143
    v_mfma_f32_16x16x32_bf16 v[132:135], v[176:179], v[236:239], 0
    ds_read_b64_tr_b16 v[250:251], v18 offset:9216
    v_mfma_f32_16x16x32_bf16 v[136:139], v[180:183], v[236:239], 0
    ds_read_b64_tr_b16 v[252:253], v19 offset:8192
    v_mfma_f32_16x16x32_bf16 v[140:143], v[184:187], v[236:239], 0
    ds_read_b64_tr_b16 v[254:255], v19 offset:9216
    s_waitcnt lgkmcnt(6)
    v_mfma_f32_16x16x32_bf16 v[24:27], v[144:147], v[200:203], v[24:27]
    ds_read_b128 v[176:179], v10 offset:0
    v_mfma_f32_16x16x32_bf16 v[28:31], v[144:147], v[204:207], v[28:31]
    ds_read_b64_tr_b16 v[224:225], v16 offset:20480
    v_mfma_f32_16x16x32_bf16 v[32:35], v[144:147], v[208:211], v[32:35]
    ds_read_b64_tr_b16 v[226:227], v16 offset:21504
    v_mfma_f32_16x16x32_bf16 v[36:39], v[148:151], v[200:203], v[36:39]
    ds_read_b128 v[180:183], v10 offset:4096
    v_mfma_f32_16x16x32_bf16 v[40:43], v[148:151], v[204:207], v[40:43]
    ds_read_b128 v[184:187], v10 offset:8192
    v_mfma_f32_16x16x32_bf16 v[44:47], v[148:151], v[208:211], v[44:47]
    ds_read_b64_tr_b16 v[228:229], v17 offset:20480
    v_mfma_f32_16x16x32_bf16 v[48:51], v[152:155], v[200:203], v[48:51]
    ds_read_b64_tr_b16 v[230:231], v17 offset:21504
    v_mfma_f32_16x16x32_bf16 v[52:55], v[152:155], v[204:207], v[52:55]
    ds_read_b64_tr_b16 v[232:233], v18 offset:20480
    v_mfma_f32_16x16x32_bf16 v[56:59], v[152:155], v[208:211], v[56:59]
    ds_read_b64_tr_b16 v[234:235], v18 offset:21504
    v_mfma_f32_16x16x32_bf16 v[60:63], v[156:159], v[200:203], v[60:63]
    ds_read_b64_tr_b16 v[236:237], v19 offset:20480
    v_mfma_f32_16x16x32_bf16 v[64:67], v[156:159], v[204:207], v[64:67]
    ds_read_b64_tr_b16 v[238:239], v19 offset:21504
    v_mfma_f32_16x16x32_bf16 v[68:71], v[156:159], v[208:211], v[68:71]
    ds_read_b128 v[212:215], v5 offset:12288
    v_mfma_f32_16x16x32_bf16 v[96:99], v[188:191], v[240:243], v[96:99]
    ds_read_b128 v[216:219], v5 offset:13312
    v_mfma_f32_16x16x32_bf16 v[100:103], v[192:195], v[240:243], v[100:103]
    ds_read_b128 v[220:223], v5 offset:14336
    v_mfma_f32_16x16x32_bf16 v[104:107], v[196:199], v[240:243], v[104:107]
    s_waitcnt lgkmcnt(12)
    v_mfma_f32_16x16x32_bf16 v[108:111], v[188:191], v[244:247], v[108:111]
    v_mfma_f32_16x16x32_bf16 v[112:115], v[192:195], v[244:247], v[112:115]
    v_mfma_f32_16x16x32_bf16 v[116:119], v[196:199], v[244:247], v[116:119]
    v_mfma_f32_16x16x32_bf16 v[120:123], v[188:191], v[248:251], v[120:123]
    v_mfma_f32_16x16x32_bf16 v[124:127], v[192:195], v[248:251], v[124:127]
    v_mfma_f32_16x16x32_bf16 v[128:131], v[196:199], v[248:251], v[128:131]
    v_mfma_f32_16x16x32_bf16 v[132:135], v[188:191], v[252:255], v[132:135]
    ds_read_b128 v[188:191], v11 offset:0
    v_mfma_f32_16x16x32_bf16 v[136:139], v[192:195], v[252:255], v[136:139]
    ds_read_b64_tr_b16 v[240:241], v16 offset:28672
    v_mfma_f32_16x16x32_bf16 v[140:143], v[196:199], v[252:255], v[140:143]
    ds_read_b64_tr_b16 v[242:243], v16 offset:29696
    s_waitcnt lgkmcnt(8)
    v_mfma_f32_16x16x32_bf16 v[96:99], v[176:179], v[224:227], v[96:99]
    ds_read_b128 v[192:195], v11 offset:4096
    v_mfma_f32_16x16x32_bf16 v[100:103], v[180:183], v[224:227], v[100:103]
    ds_read_b128 v[196:199], v11 offset:8192
    v_mfma_f32_16x16x32_bf16 v[104:107], v[184:187], v[224:227], v[104:107]
    ds_read_b64_tr_b16 v[244:245], v17 offset:28672
    v_mfma_f32_16x16x32_bf16 v[108:111], v[176:179], v[228:231], v[108:111]
    ds_read_b64_tr_b16 v[246:247], v17 offset:29696
    v_mfma_f32_16x16x32_bf16 v[112:115], v[180:183], v[228:231], v[112:115]
    ds_read_b64_tr_b16 v[248:249], v18 offset:28672
    v_mfma_f32_16x16x32_bf16 v[116:119], v[184:187], v[228:231], v[116:119]
    ds_read_b64_tr_b16 v[250:251], v18 offset:29696
    v_mfma_f32_16x16x32_bf16 v[120:123], v[176:179], v[232:235], v[120:123]
    ds_read_b64_tr_b16 v[252:253], v19 offset:28672
    v_mfma_f32_16x16x32_bf16 v[124:127], v[180:183], v[232:235], v[124:127]
    ds_read_b64_tr_b16 v[254:255], v19 offset:29696
    v_mfma_f32_16x16x32_bf16 v[128:131], v[184:187], v[232:235], v[128:131]
    s_waitcnt lgkmcnt(11)
    v_mfma_f32_16x16x32_bf16 v[132:135], v[176:179], v[236:239], v[132:135]
    v_mfma_f32_16x16x32_bf16 v[136:139], v[180:183], v[236:239], v[136:139]
    v_mfma_f32_16x16x32_bf16 v[140:143], v[184:187], v[236:239], v[140:143]
    v_mfma_f32_16x16x32_bf16 v[24:27], v[160:163], v[212:215], v[24:27]
    v_mfma_f32_16x16x32_bf16 v[28:31], v[160:163], v[216:219], v[28:31]
    v_mfma_f32_16x16x32_bf16 v[32:35], v[160:163], v[220:223], v[32:35]
    v_mfma_f32_16x16x32_bf16 v[36:39], v[164:167], v[212:215], v[36:39]
    v_mfma_f32_16x16x32_bf16 v[40:43], v[164:167], v[216:219], v[40:43]
    s_waitcnt lgkmcnt(0)
    s_barrier
    v_mfma_f32_16x16x32_bf16 v[44:47], v[164:167], v[220:223], v[44:47]
    ds_read_b128 v[176:179], v8 offset:0
    v_mfma_f32_16x16x32_bf16 v[48:51], v[168:171], v[212:215], v[48:51]
    ds_read_b64_tr_b16 v[224:225], v16 offset:36864
    v_mfma_f32_16x16x32_bf16 v[52:55], v[168:171], v[216:219], v[52:55]
    ds_read_b64_tr_b16 v[226:227], v16 offset:37888
    v_mfma_f32_16x16x32_bf16 v[56:59], v[168:171], v[220:223], v[56:59]
    ds_read_b128 v[180:183], v8 offset:4096
    v_mfma_f32_16x16x32_bf16 v[60:63], v[172:175], v[212:215], v[60:63]
    ds_read_b128 v[184:187], v8 offset:8192
    v_mfma_f32_16x16x32_bf16 v[64:67], v[172:175], v[216:219], v[64:67]
    ds_read_b64_tr_b16 v[228:229], v17 offset:36864
    v_mfma_f32_16x16x32_bf16 v[68:71], v[172:175], v[220:223], v[68:71]
    ds_read_b64_tr_b16 v[230:231], v17 offset:37888
    v_mfma_f32_16x16x32_bf16 v[96:99], v[188:191], v[240:243], v[96:99]
    ds_read_b64_tr_b16 v[232:233], v18 offset:36864
    v_mfma_f32_16x16x32_bf16 v[100:103], v[192:195], v[240:243], v[100:103]
    ds_read_b64_tr_b16 v[234:235], v18 offset:37888
    v_mfma_f32_16x16x32_bf16 v[104:107], v[196:199], v[240:243], v[104:107]
    ds_read_b64_tr_b16 v[236:237], v19 offset:36864
    v_mfma_f32_16x16x32_bf16 v[108:111], v[188:191], v[244:247], v[108:111]
    ds_read_b64_tr_b16 v[238:239], v19 offset:37888
    s_nop 0
    v_cvt_pk_bf16_f32 v144, v96, v97
    v_mfma_f32_16x16x32_bf16 v[112:115], v[192:195], v[244:247], v[112:115]
    v_cvt_pk_bf16_f32 v145, v98, v99
    v_cvt_pk_bf16_f32 v146, v100, v101
    v_mfma_f32_16x16x32_bf16 v[116:119], v[196:199], v[244:247], v[116:119]
    v_cvt_pk_bf16_f32 v147, v102, v103
    v_cvt_pk_bf16_f32 v160, v104, v105
    v_mfma_f32_16x16x32_bf16 v[120:123], v[188:191], v[248:251], v[120:123]
    v_cvt_pk_bf16_f32 v161, v106, v107
    v_cvt_pk_bf16_f32 v148, v108, v109
    v_mfma_f32_16x16x32_bf16 v[124:127], v[192:195], v[248:251], v[124:127]
    v_cvt_pk_bf16_f32 v149, v110, v111
    v_cvt_pk_bf16_f32 v150, v112, v113
    v_mfma_f32_16x16x32_bf16 v[128:131], v[196:199], v[248:251], v[128:131]
    v_cvt_pk_bf16_f32 v151, v114, v115
    v_cvt_pk_bf16_f32 v164, v116, v117
    v_mfma_f32_16x16x32_bf16 v[132:135], v[188:191], v[252:255], v[132:135]
    v_cvt_pk_bf16_f32 v165, v118, v119
    ds_read_b128 v[188:191], v9 offset:0
    v_mfma_f32_16x16x32_bf16 v[136:139], v[192:195], v[252:255], v[136:139]
    v_cvt_pk_bf16_f32 v152, v120, v121
    v_cvt_pk_bf16_f32 v153, v122, v123
    v_mfma_f32_16x16x32_bf16 v[140:143], v[196:199], v[252:255], v[140:143]
    ds_read_b64_tr_b16 v[240:241], v16 offset:45056
    v_cvt_pk_bf16_f32 v154, v124, v125
    s_waitcnt lgkmcnt(2)
    v_mfma_f32_16x16x32_bf16 v[96:99], v[176:179], v[224:227], 0
    ds_read_b64_tr_b16 v[242:243], v16 offset:46080
    v_cvt_pk_bf16_f32 v156, v132, v133
    v_mfma_f32_16x16x32_bf16 v[100:103], v[180:183], v[224:227], 0
    ds_read_b128 v[192:195], v9 offset:4096
    v_cvt_pk_bf16_f32 v157, v134, v135
    v_mfma_f32_16x16x32_bf16 v[104:107], v[184:187], v[224:227], 0
    v_cvt_pk_bf16_f32 v155, v126, v127
    ds_read_b128 v[196:199], v9 offset:8192
    v_mfma_f32_16x16x32_bf16 v[108:111], v[176:179], v[228:231], 0
    v_cvt_pk_bf16_f32 v158, v136, v137
    v_cvt_pk_bf16_f32 v159, v138, v139
    v_mfma_f32_16x16x32_bf16 v[112:115], v[180:183], v[228:231], 0
    ds_read_b64_tr_b16 v[244:245], v17 offset:45056
    v_cvt_pk_bf16_f32 v168, v128, v129
    v_mfma_f32_16x16x32_bf16 v[116:119], v[184:187], v[228:231], 0
    ds_read_b64_tr_b16 v[246:247], v17 offset:46080
    v_cvt_pk_bf16_f32 v169, v130, v131
    v_mfma_f32_16x16x32_bf16 v[120:123], v[176:179], v[232:235], 0
    ds_read_b64_tr_b16 v[248:249], v18 offset:45056
    v_cvt_pk_bf16_f32 v172, v140, v141
    v_mfma_f32_16x16x32_bf16 v[124:127], v[180:183], v[232:235], 0
    v_cvt_pk_bf16_f32 v173, v142, v143
    ds_read_b64_tr_b16 v[250:251], v18 offset:46080
    v_mfma_f32_16x16x32_bf16 v[128:131], v[184:187], v[232:235], 0
    ds_read_b64_tr_b16 v[252:253], v19 offset:45056
    v_mfma_f32_16x16x32_bf16 v[132:135], v[176:179], v[236:239], 0
    ds_read_b64_tr_b16 v[254:255], v19 offset:46080
    v_mfma_f32_16x16x32_bf16 v[136:139], v[180:183], v[236:239], 0
    ds_read_b128 v[176:179], v10 offset:0
    v_mfma_f32_16x16x32_bf16 v[140:143], v[184:187], v[236:239], 0
    ds_read_b64_tr_b16 v[224:225], v20 offset:0
    s_waitcnt lgkmcnt(9)
    v_mfma_f32_16x16x32_bf16 v[96:99], v[188:191], v[240:243], v[96:99]
    ds_read_b64_tr_b16 v[226:227], v20 offset:1024
    v_mfma_f32_16x16x32_bf16 v[100:103], v[192:195], v[240:243], v[100:103]
    ds_read_b128 v[180:183], v10 offset:4096
    s_waitcnt lgkmcnt(10)
    v_mfma_f32_16x16x32_bf16 v[104:107], v[196:199], v[240:243], v[104:107]
    ds_read_b128 v[184:187], v10 offset:8192
    s_waitcnt lgkmcnt(9)
    v_mfma_f32_16x16x32_bf16 v[108:111], v[188:191], v[244:247], v[108:111]
    ds_read_b64_tr_b16 v[228:229], v21 offset:0
    v_mfma_f32_16x16x32_bf16 v[112:115], v[192:195], v[244:247], v[112:115]
    ds_read_b64_tr_b16 v[230:231], v21 offset:1024
    v_mfma_f32_16x16x32_bf16 v[116:119], v[196:199], v[244:247], v[116:119]
    ds_read_b64_tr_b16 v[232:233], v22 offset:0
    s_waitcnt lgkmcnt(10)
    v_mfma_f32_16x16x32_bf16 v[120:123], v[188:191], v[248:251], v[120:123]
    ds_read_b64_tr_b16 v[234:235], v22 offset:1024
    v_mfma_f32_16x16x32_bf16 v[124:127], v[192:195], v[248:251], v[124:127]
    ds_read_b64_tr_b16 v[236:237], v23 offset:0
    v_mfma_f32_16x16x32_bf16 v[128:131], v[196:199], v[248:251], v[128:131]
    ds_read_b64_tr_b16 v[238:239], v23 offset:1024
    s_waitcnt lgkmcnt(10)
    v_mfma_f32_16x16x32_bf16 v[132:135], v[188:191], v[252:255], v[132:135]
    ds_read_b128 v[212:215], v5 offset:0
    v_mfma_f32_16x16x32_bf16 v[136:139], v[192:195], v[252:255], v[136:139]
    ds_read_b128 v[216:219], v5 offset:1024
    v_mfma_f32_16x16x32_bf16 v[140:143], v[196:199], v[252:255], v[140:143]
    ds_read_b128 v[220:223], v5 offset:2048
    s_waitcnt lgkmcnt(10)
    v_mfma_f32_16x16x32_bf16 v[96:99], v[176:179], v[224:227], v[96:99]
    ds_read_b128 v[188:191], v11 offset:0
    v_mfma_f32_16x16x32_bf16 v[100:103], v[180:183], v[224:227], v[100:103]
    s_waitcnt lgkmcnt(10)
    v_mfma_f32_16x16x32_bf16 v[104:107], v[184:187], v[224:227], v[104:107]
    ds_read_b64_tr_b16 v[240:241], v20 offset:8192
    s_waitcnt lgkmcnt(9)
    v_mfma_f32_16x16x32_bf16 v[108:111], v[176:179], v[228:231], v[108:111]
    ds_read_b64_tr_b16 v[242:243], v20 offset:9216
    v_mfma_f32_16x16x32_bf16 v[112:115], v[180:183], v[228:231], v[112:115]
    ds_read_b128 v[192:195], v11 offset:4096
    v_mfma_f32_16x16x32_bf16 v[116:119], v[184:187], v[228:231], v[116:119]
    ds_read_b128 v[196:199], v11 offset:8192
    s_waitcnt lgkmcnt(10)
    v_mfma_f32_16x16x32_bf16 v[120:123], v[176:179], v[232:235], v[120:123]
    ds_read_b64_tr_b16 v[244:245], v21 offset:8192
    v_mfma_f32_16x16x32_bf16 v[124:127], v[180:183], v[232:235], v[124:127]
    ds_read_b64_tr_b16 v[246:247], v21 offset:9216
    v_mfma_f32_16x16x32_bf16 v[128:131], v[184:187], v[232:235], v[128:131]
    ds_read_b64_tr_b16 v[248:249], v22 offset:8192
    s_waitcnt lgkmcnt(10)
    v_mfma_f32_16x16x32_bf16 v[132:135], v[176:179], v[236:239], v[132:135]
    ds_read_b64_tr_b16 v[250:251], v22 offset:9216
    v_mfma_f32_16x16x32_bf16 v[136:139], v[180:183], v[236:239], v[136:139]
    ds_read_b64_tr_b16 v[252:253], v23 offset:8192
    v_mfma_f32_16x16x32_bf16 v[140:143], v[184:187], v[236:239], v[140:143]
    ds_read_b64_tr_b16 v[254:255], v23 offset:9216
    v_mfma_f32_16x16x32_bf16 v[24:27], v[144:147], v[212:215], v[24:27]
    s_waitcnt lgkmcnt(10)
    v_mfma_f32_16x16x32_bf16 v[28:31], v[144:147], v[216:219], v[28:31]
    v_mfma_f32_16x16x32_bf16 v[32:35], v[144:147], v[220:223], v[32:35]
    v_mfma_f32_16x16x32_bf16 v[36:39], v[148:151], v[212:215], v[36:39]
    v_mfma_f32_16x16x32_bf16 v[40:43], v[148:151], v[216:219], v[40:43]
    s_waitcnt lgkmcnt(0)
    s_barrier
    v_mfma_f32_16x16x32_bf16 v[44:47], v[148:151], v[220:223], v[44:47]
    ds_read_b128 v[176:179], v12 offset:0
    v_mfma_f32_16x16x32_bf16 v[48:51], v[152:155], v[212:215], v[48:51]
    ds_read_b64_tr_b16 v[224:225], v20 offset:16384
    v_mfma_f32_16x16x32_bf16 v[52:55], v[152:155], v[216:219], v[52:55]
    ds_read_b64_tr_b16 v[226:227], v20 offset:17408
    v_mfma_f32_16x16x32_bf16 v[56:59], v[152:155], v[220:223], v[56:59]
    ds_read_b128 v[180:183], v12 offset:4096
    v_mfma_f32_16x16x32_bf16 v[60:63], v[156:159], v[212:215], v[60:63]
    ds_read_b128 v[184:187], v12 offset:8192
    v_mfma_f32_16x16x32_bf16 v[64:67], v[156:159], v[216:219], v[64:67]
    ds_read_b64_tr_b16 v[228:229], v21 offset:16384
    v_mfma_f32_16x16x32_bf16 v[68:71], v[156:159], v[220:223], v[68:71]
    ds_read_b64_tr_b16 v[230:231], v21 offset:17408
    v_mfma_f32_16x16x32_bf16 v[96:99], v[188:191], v[240:243], v[96:99]
    ds_read_b64_tr_b16 v[232:233], v22 offset:16384
    v_mfma_f32_16x16x32_bf16 v[100:103], v[192:195], v[240:243], v[100:103]
    ds_read_b64_tr_b16 v[234:235], v22 offset:17408
    v_mfma_f32_16x16x32_bf16 v[104:107], v[196:199], v[240:243], v[104:107]
    ds_read_b64_tr_b16 v[236:237], v23 offset:16384
    v_mfma_f32_16x16x32_bf16 v[108:111], v[188:191], v[244:247], v[108:111]
    ds_read_b64_tr_b16 v[238:239], v23 offset:17408
    s_nop 0
    v_cvt_pk_bf16_f32 v144, v96, v97
    v_mfma_f32_16x16x32_bf16 v[112:115], v[192:195], v[244:247], v[112:115]
    ds_read_b128 v[200:203], v5 offset:6144
    v_cvt_pk_bf16_f32 v145, v98, v99
    v_mfma_f32_16x16x32_bf16 v[116:119], v[196:199], v[244:247], v[116:119]
    v_cvt_pk_bf16_f32 v146, v100, v101
    ds_read_b128 v[204:207], v5 offset:7168
    v_mfma_f32_16x16x32_bf16 v[120:123], v[188:191], v[248:251], v[120:123]
    v_cvt_pk_bf16_f32 v147, v102, v103
    v_cvt_pk_bf16_f32 v148, v108, v109
    v_mfma_f32_16x16x32_bf16 v[124:127], v[192:195], v[248:251], v[124:127]
    ds_read_b128 v[208:211], v5 offset:8192
    v_cvt_pk_bf16_f32 v149, v110, v111
    v_mfma_f32_16x16x32_bf16 v[128:131], v[196:199], v[248:251], v[128:131]
    v_cvt_pk_bf16_f32 v162, v104, v105
    v_cvt_pk_bf16_f32 v163, v106, v107
    v_mfma_f32_16x16x32_bf16 v[132:135], v[188:191], v[252:255], v[132:135]
    v_cvt_pk_bf16_f32 v150, v112, v113
    ds_read_b128 v[188:191], v13 offset:0
    v_mfma_f32_16x16x32_bf16 v[136:139], v[192:195], v[252:255], v[136:139]
    v_cvt_pk_bf16_f32 v152, v120, v121
    v_cvt_pk_bf16_f32 v153, v122, v123
    v_mfma_f32_16x16x32_bf16 v[140:143], v[196:199], v[252:255], v[140:143]
    ds_read_b64_tr_b16 v[240:241], v20 offset:24576
    v_cvt_pk_bf16_f32 v151, v114, v115
    s_waitcnt lgkmcnt(5)
    v_mfma_f32_16x16x32_bf16 v[96:99], v[176:179], v[224:227], 0
    ds_read_b64_tr_b16 v[242:243], v20 offset:25600
    v_cvt_pk_bf16_f32 v156, v132, v133
    v_mfma_f32_16x16x32_bf16 v[100:103], v[180:183], v[224:227], 0
    ds_read_b128 v[192:195], v13 offset:4096
    v_cvt_pk_bf16_f32 v157, v134, v135
    v_mfma_f32_16x16x32_bf16 v[104:107], v[184:187], v[224:227], 0
    v_cvt_pk_bf16_f32 v154, v124, v125
    ds_read_b128 v[196:199], v13 offset:8192
    v_mfma_f32_16x16x32_bf16 v[108:111], v[176:179], v[228:231], 0
    v_cvt_pk_bf16_f32 v155, v126, v127
    v_cvt_pk_bf16_f32 v158, v136, v137
    v_mfma_f32_16x16x32_bf16 v[112:115], v[180:183], v[228:231], 0
    ds_read_b64_tr_b16 v[244:245], v21 offset:24576
    v_cvt_pk_bf16_f32 v159, v138, v139
    v_mfma_f32_16x16x32_bf16 v[120:123], v[176:179], v[232:235], 0
    ds_read_b64_tr_b16 v[246:247], v21 offset:25600
    v_cvt_pk_bf16_f32 v166, v116, v117
    v_mfma_f32_16x16x32_bf16 v[124:127], v[180:183], v[232:235], 0
    ds_read_b64_tr_b16 v[248:249], v22 offset:24576
    v_cvt_pk_bf16_f32 v167, v118, v119
    v_mfma_f32_16x16x32_bf16 v[116:119], v[184:187], v[228:231], 0
    v_cvt_pk_bf16_f32 v170, v128, v129
    v_cvt_pk_bf16_f32 v171, v130, v131
    v_mfma_f32_16x16x32_bf16 v[128:131], v[184:187], v[232:235], 0
    v_cvt_pk_bf16_f32 v174, v140, v141
    v_cvt_pk_bf16_f32 v175, v142, v143
    v_mfma_f32_16x16x32_bf16 v[132:135], v[176:179], v[236:239], 0
    ds_read_b64_tr_b16 v[250:251], v22 offset:25600
    v_mfma_f32_16x16x32_bf16 v[136:139], v[180:183], v[236:239], 0
    ds_read_b64_tr_b16 v[252:253], v23 offset:24576
    v_mfma_f32_16x16x32_bf16 v[140:143], v[184:187], v[236:239], 0
    ds_read_b64_tr_b16 v[254:255], v23 offset:25600
    s_waitcnt lgkmcnt(6)
    v_mfma_f32_16x16x32_bf16 v[24:27], v[144:147], v[200:203], v[24:27]
    ds_read_b128 v[176:179], v14 offset:0
    v_mfma_f32_16x16x32_bf16 v[28:31], v[144:147], v[204:207], v[28:31]
    ds_read_b64_tr_b16 v[224:225], v16 offset:0
    v_mfma_f32_16x16x32_bf16 v[32:35], v[144:147], v[208:211], v[32:35]
    ds_read_b64_tr_b16 v[226:227], v16 offset:1024
    v_mfma_f32_16x16x32_bf16 v[36:39], v[148:151], v[200:203], v[36:39]
    ds_read_b128 v[180:183], v14 offset:4096
    v_mfma_f32_16x16x32_bf16 v[40:43], v[148:151], v[204:207], v[40:43]
    ds_read_b128 v[184:187], v14 offset:8192
    v_mfma_f32_16x16x32_bf16 v[44:47], v[148:151], v[208:211], v[44:47]
    ds_read_b64_tr_b16 v[228:229], v17 offset:0
    v_mfma_f32_16x16x32_bf16 v[48:51], v[152:155], v[200:203], v[48:51]
    ds_read_b64_tr_b16 v[230:231], v17 offset:1024
    v_mfma_f32_16x16x32_bf16 v[52:55], v[152:155], v[204:207], v[52:55]
    ds_read_b64_tr_b16 v[232:233], v18 offset:0
    v_mfma_f32_16x16x32_bf16 v[56:59], v[152:155], v[208:211], v[56:59]
    ds_read_b64_tr_b16 v[234:235], v18 offset:1024
    v_mfma_f32_16x16x32_bf16 v[60:63], v[156:159], v[200:203], v[60:63]
    ds_read_b64_tr_b16 v[236:237], v19 offset:0
    v_mfma_f32_16x16x32_bf16 v[64:67], v[156:159], v[204:207], v[64:67]
    ds_read_b64_tr_b16 v[238:239], v19 offset:1024
    v_mfma_f32_16x16x32_bf16 v[68:71], v[156:159], v[208:211], v[68:71]
    ds_read_b128 v[212:215], v5 offset:12288
    v_mfma_f32_16x16x32_bf16 v[96:99], v[188:191], v[240:243], v[96:99]
    ds_read_b128 v[216:219], v5 offset:13312
    v_mfma_f32_16x16x32_bf16 v[100:103], v[192:195], v[240:243], v[100:103]
    ds_read_b128 v[220:223], v5 offset:14336
    v_mfma_f32_16x16x32_bf16 v[104:107], v[196:199], v[240:243], v[104:107]
    s_waitcnt lgkmcnt(12)
    v_mfma_f32_16x16x32_bf16 v[108:111], v[188:191], v[244:247], v[108:111]
    v_mfma_f32_16x16x32_bf16 v[112:115], v[192:195], v[244:247], v[112:115]
    v_mfma_f32_16x16x32_bf16 v[116:119], v[196:199], v[244:247], v[116:119]
    v_mfma_f32_16x16x32_bf16 v[120:123], v[188:191], v[248:251], v[120:123]
    v_mfma_f32_16x16x32_bf16 v[124:127], v[192:195], v[248:251], v[124:127]
    v_mfma_f32_16x16x32_bf16 v[128:131], v[196:199], v[248:251], v[128:131]
    v_mfma_f32_16x16x32_bf16 v[132:135], v[188:191], v[252:255], v[132:135]
    ds_read_b128 v[188:191], v15 offset:0
    v_mfma_f32_16x16x32_bf16 v[136:139], v[192:195], v[252:255], v[136:139]
    ds_read_b64_tr_b16 v[240:241], v16 offset:8192
    v_mfma_f32_16x16x32_bf16 v[140:143], v[196:199], v[252:255], v[140:143]
    ds_read_b64_tr_b16 v[242:243], v16 offset:9216
    s_waitcnt lgkmcnt(8)
    v_mfma_f32_16x16x32_bf16 v[96:99], v[176:179], v[224:227], v[96:99]
    ds_read_b128 v[192:195], v15 offset:4096
    v_mfma_f32_16x16x32_bf16 v[100:103], v[180:183], v[224:227], v[100:103]
    ds_read_b128 v[196:199], v15 offset:8192
    v_mfma_f32_16x16x32_bf16 v[104:107], v[184:187], v[224:227], v[104:107]
    ds_read_b64_tr_b16 v[244:245], v17 offset:8192
    v_mfma_f32_16x16x32_bf16 v[108:111], v[176:179], v[228:231], v[108:111]
    ds_read_b64_tr_b16 v[246:247], v17 offset:9216
    v_mfma_f32_16x16x32_bf16 v[112:115], v[180:183], v[228:231], v[112:115]
    ds_read_b64_tr_b16 v[248:249], v18 offset:8192
    v_mfma_f32_16x16x32_bf16 v[116:119], v[184:187], v[228:231], v[116:119]
    ds_read_b64_tr_b16 v[250:251], v18 offset:9216
    v_mfma_f32_16x16x32_bf16 v[120:123], v[176:179], v[232:235], v[120:123]
    ds_read_b64_tr_b16 v[252:253], v19 offset:8192
    v_mfma_f32_16x16x32_bf16 v[124:127], v[180:183], v[232:235], v[124:127]
    ds_read_b64_tr_b16 v[254:255], v19 offset:9216
    v_mfma_f32_16x16x32_bf16 v[128:131], v[184:187], v[232:235], v[128:131]
    s_waitcnt lgkmcnt(11)
    v_mfma_f32_16x16x32_bf16 v[132:135], v[176:179], v[236:239], v[132:135]
    v_mfma_f32_16x16x32_bf16 v[136:139], v[180:183], v[236:239], v[136:139]
    v_mfma_f32_16x16x32_bf16 v[140:143], v[184:187], v[236:239], v[140:143]
    v_mfma_f32_16x16x32_bf16 v[24:27], v[160:163], v[212:215], v[24:27]
    v_mfma_f32_16x16x32_bf16 v[28:31], v[160:163], v[216:219], v[28:31]
    v_mfma_f32_16x16x32_bf16 v[32:35], v[160:163], v[220:223], v[32:35]
    v_mfma_f32_16x16x32_bf16 v[36:39], v[164:167], v[212:215], v[36:39]
    v_mfma_f32_16x16x32_bf16 v[40:43], v[164:167], v[216:219], v[40:43]
    s_waitcnt lgkmcnt(0)
    s_barrier
    v_mfma_f32_16x16x32_bf16 v[44:47], v[164:167], v[220:223], v[44:47]
    ds_read_b128 v[176:179], v12 offset:0
    v_mfma_f32_16x16x32_bf16 v[48:51], v[168:171], v[212:215], v[48:51]
    ds_read_b64_tr_b16 v[224:225], v16 offset:20480
    v_mfma_f32_16x16x32_bf16 v[52:55], v[168:171], v[216:219], v[52:55]
    ds_read_b64_tr_b16 v[226:227], v16 offset:21504
    v_mfma_f32_16x16x32_bf16 v[56:59], v[168:171], v[220:223], v[56:59]
    ds_read_b128 v[180:183], v12 offset:4096
    v_mfma_f32_16x16x32_bf16 v[60:63], v[172:175], v[212:215], v[60:63]
    ds_read_b128 v[184:187], v12 offset:8192
    v_mfma_f32_16x16x32_bf16 v[64:67], v[172:175], v[216:219], v[64:67]
    ds_read_b64_tr_b16 v[228:229], v17 offset:20480
    v_mfma_f32_16x16x32_bf16 v[68:71], v[172:175], v[220:223], v[68:71]
    ds_read_b64_tr_b16 v[230:231], v17 offset:21504
    v_mfma_f32_16x16x32_bf16 v[96:99], v[188:191], v[240:243], v[96:99]
    ds_read_b64_tr_b16 v[232:233], v18 offset:20480
    v_mfma_f32_16x16x32_bf16 v[100:103], v[192:195], v[240:243], v[100:103]
    ds_read_b64_tr_b16 v[234:235], v18 offset:21504
    v_mfma_f32_16x16x32_bf16 v[104:107], v[196:199], v[240:243], v[104:107]
    ds_read_b64_tr_b16 v[236:237], v19 offset:20480
    v_mfma_f32_16x16x32_bf16 v[108:111], v[188:191], v[244:247], v[108:111]
    ds_read_b64_tr_b16 v[238:239], v19 offset:21504
    s_nop 0
    v_cvt_pk_bf16_f32 v144, v96, v97
    v_mfma_f32_16x16x32_bf16 v[112:115], v[192:195], v[244:247], v[112:115]
    v_cvt_pk_bf16_f32 v145, v98, v99
    v_cvt_pk_bf16_f32 v146, v100, v101
    v_mfma_f32_16x16x32_bf16 v[116:119], v[196:199], v[244:247], v[116:119]
    v_cvt_pk_bf16_f32 v147, v102, v103
    v_cvt_pk_bf16_f32 v160, v104, v105
    v_mfma_f32_16x16x32_bf16 v[120:123], v[188:191], v[248:251], v[120:123]
    v_cvt_pk_bf16_f32 v161, v106, v107
    v_cvt_pk_bf16_f32 v148, v108, v109
    v_mfma_f32_16x16x32_bf16 v[124:127], v[192:195], v[248:251], v[124:127]
    v_cvt_pk_bf16_f32 v149, v110, v111
    v_cvt_pk_bf16_f32 v150, v112, v113
    v_mfma_f32_16x16x32_bf16 v[128:131], v[196:199], v[248:251], v[128:131]
    v_cvt_pk_bf16_f32 v151, v114, v115
    v_cvt_pk_bf16_f32 v164, v116, v117
    v_mfma_f32_16x16x32_bf16 v[132:135], v[188:191], v[252:255], v[132:135]
    v_cvt_pk_bf16_f32 v165, v118, v119
    ds_read_b128 v[188:191], v13 offset:0
    v_mfma_f32_16x16x32_bf16 v[136:139], v[192:195], v[252:255], v[136:139]
    v_cvt_pk_bf16_f32 v152, v120, v121
    v_cvt_pk_bf16_f32 v153, v122, v123
    v_mfma_f32_16x16x32_bf16 v[140:143], v[196:199], v[252:255], v[140:143]
    ds_read_b64_tr_b16 v[240:241], v16 offset:28672
    v_cvt_pk_bf16_f32 v154, v124, v125
    s_waitcnt lgkmcnt(2)
    v_mfma_f32_16x16x32_bf16 v[96:99], v[176:179], v[224:227], 0
    ds_read_b64_tr_b16 v[242:243], v16 offset:29696
    v_cvt_pk_bf16_f32 v156, v132, v133
    v_mfma_f32_16x16x32_bf16 v[100:103], v[180:183], v[224:227], 0
    ds_read_b128 v[192:195], v13 offset:4096
    v_cvt_pk_bf16_f32 v157, v134, v135
    v_mfma_f32_16x16x32_bf16 v[104:107], v[184:187], v[224:227], 0
    v_cvt_pk_bf16_f32 v155, v126, v127
    ds_read_b128 v[196:199], v13 offset:8192
    v_mfma_f32_16x16x32_bf16 v[108:111], v[176:179], v[228:231], 0
    v_cvt_pk_bf16_f32 v158, v136, v137
    v_cvt_pk_bf16_f32 v159, v138, v139
    v_mfma_f32_16x16x32_bf16 v[112:115], v[180:183], v[228:231], 0
    ds_read_b64_tr_b16 v[244:245], v17 offset:28672
    v_cvt_pk_bf16_f32 v168, v128, v129
    v_mfma_f32_16x16x32_bf16 v[116:119], v[184:187], v[228:231], 0
    ds_read_b64_tr_b16 v[246:247], v17 offset:29696
    v_cvt_pk_bf16_f32 v169, v130, v131
    v_mfma_f32_16x16x32_bf16 v[120:123], v[176:179], v[232:235], 0
    ds_read_b64_tr_b16 v[248:249], v18 offset:28672
    v_cvt_pk_bf16_f32 v172, v140, v141
    v_mfma_f32_16x16x32_bf16 v[124:127], v[180:183], v[232:235], 0
    v_cvt_pk_bf16_f32 v173, v142, v143
    ds_read_b64_tr_b16 v[250:251], v18 offset:29696
    v_mfma_f32_16x16x32_bf16 v[128:131], v[184:187], v[232:235], 0
    ds_read_b64_tr_b16 v[252:253], v19 offset:28672
    v_mfma_f32_16x16x32_bf16 v[132:135], v[176:179], v[236:239], 0
    ds_read_b64_tr_b16 v[254:255], v19 offset:29696
    v_mfma_f32_16x16x32_bf16 v[136:139], v[180:183], v[236:239], 0
    ds_read_b128 v[176:179], v14 offset:0
    v_mfma_f32_16x16x32_bf16 v[140:143], v[184:187], v[236:239], 0
    ds_read_b64_tr_b16 v[224:225], v16 offset:36864
    s_waitcnt lgkmcnt(9)
    v_mfma_f32_16x16x32_bf16 v[96:99], v[188:191], v[240:243], v[96:99]
    ds_read_b64_tr_b16 v[226:227], v16 offset:37888
    v_mfma_f32_16x16x32_bf16 v[100:103], v[192:195], v[240:243], v[100:103]
    ds_read_b128 v[180:183], v14 offset:4096
    s_waitcnt lgkmcnt(10)
    v_mfma_f32_16x16x32_bf16 v[104:107], v[196:199], v[240:243], v[104:107]
    ds_read_b128 v[184:187], v14 offset:8192
    s_waitcnt lgkmcnt(9)
    v_mfma_f32_16x16x32_bf16 v[108:111], v[188:191], v[244:247], v[108:111]
    ds_read_b64_tr_b16 v[228:229], v17 offset:36864
    v_mfma_f32_16x16x32_bf16 v[112:115], v[192:195], v[244:247], v[112:115]
    ds_read_b64_tr_b16 v[230:231], v17 offset:37888
    v_mfma_f32_16x16x32_bf16 v[116:119], v[196:199], v[244:247], v[116:119]
    ds_read_b64_tr_b16 v[232:233], v18 offset:36864
    s_waitcnt lgkmcnt(10)
    v_mfma_f32_16x16x32_bf16 v[120:123], v[188:191], v[248:251], v[120:123]
    ds_read_b64_tr_b16 v[234:235], v18 offset:37888
    v_mfma_f32_16x16x32_bf16 v[124:127], v[192:195], v[248:251], v[124:127]
    ds_read_b64_tr_b16 v[236:237], v19 offset:36864
    v_mfma_f32_16x16x32_bf16 v[128:131], v[196:199], v[248:251], v[128:131]
    ds_read_b64_tr_b16 v[238:239], v19 offset:37888
    s_waitcnt lgkmcnt(10)
    v_mfma_f32_16x16x32_bf16 v[132:135], v[188:191], v[252:255], v[132:135]
    ds_read_b128 v[212:215], v5 offset:0
    v_mfma_f32_16x16x32_bf16 v[136:139], v[192:195], v[252:255], v[136:139]
    ds_read_b128 v[216:219], v5 offset:1024
    v_mfma_f32_16x16x32_bf16 v[140:143], v[196:199], v[252:255], v[140:143]
    ds_read_b128 v[220:223], v5 offset:2048
    s_waitcnt lgkmcnt(10)
    v_mfma_f32_16x16x32_bf16 v[96:99], v[176:179], v[224:227], v[96:99]
    ds_read_b128 v[188:191], v15 offset:0
    v_mfma_f32_16x16x32_bf16 v[100:103], v[180:183], v[224:227], v[100:103]
    s_waitcnt lgkmcnt(10)
    v_mfma_f32_16x16x32_bf16 v[104:107], v[184:187], v[224:227], v[104:107]
    ds_read_b64_tr_b16 v[240:241], v16 offset:45056
    s_waitcnt lgkmcnt(9)
    v_mfma_f32_16x16x32_bf16 v[108:111], v[176:179], v[228:231], v[108:111]
    ds_read_b64_tr_b16 v[242:243], v16 offset:46080
    v_mfma_f32_16x16x32_bf16 v[112:115], v[180:183], v[228:231], v[112:115]
    ds_read_b128 v[192:195], v15 offset:4096
    v_mfma_f32_16x16x32_bf16 v[116:119], v[184:187], v[228:231], v[116:119]
    ds_read_b128 v[196:199], v15 offset:8192
    s_waitcnt lgkmcnt(10)
    v_mfma_f32_16x16x32_bf16 v[120:123], v[176:179], v[232:235], v[120:123]
    ds_read_b64_tr_b16 v[244:245], v17 offset:45056
    v_mfma_f32_16x16x32_bf16 v[124:127], v[180:183], v[232:235], v[124:127]
    ds_read_b64_tr_b16 v[246:247], v17 offset:46080
    v_mfma_f32_16x16x32_bf16 v[128:131], v[184:187], v[232:235], v[128:131]
    ds_read_b64_tr_b16 v[248:249], v18 offset:45056
    s_waitcnt lgkmcnt(10)
    v_mfma_f32_16x16x32_bf16 v[132:135], v[176:179], v[236:239], v[132:135]
    ds_read_b64_tr_b16 v[250:251], v18 offset:46080
    v_mfma_f32_16x16x32_bf16 v[136:139], v[180:183], v[236:239], v[136:139]
    ds_read_b64_tr_b16 v[252:253], v19 offset:45056
    v_mfma_f32_16x16x32_bf16 v[140:143], v[184:187], v[236:239], v[140:143]
    ds_read_b64_tr_b16 v[254:255], v19 offset:46080
    v_mfma_f32_16x16x32_bf16 v[24:27], v[144:147], v[212:215], v[24:27]
    s_waitcnt lgkmcnt(10)
    v_mfma_f32_16x16x32_bf16 v[28:31], v[144:147], v[216:219], v[28:31]
    v_mfma_f32_16x16x32_bf16 v[32:35], v[144:147], v[220:223], v[32:35]
    v_mfma_f32_16x16x32_bf16 v[36:39], v[148:151], v[212:215], v[36:39]
    v_mfma_f32_16x16x32_bf16 v[40:43], v[148:151], v[216:219], v[40:43]
    s_waitcnt lgkmcnt(0)
    s_barrier
    v_mfma_f32_16x16x32_bf16 v[44:47], v[148:151], v[220:223], v[44:47]
    ds_read_b128 v[200:203], v5 offset:6144
    v_mfma_f32_16x16x32_bf16 v[48:51], v[152:155], v[212:215], v[48:51]
    ds_read_b128 v[204:207], v5 offset:7168
    v_mfma_f32_16x16x32_bf16 v[52:55], v[152:155], v[216:219], v[52:55]
    ds_read_b128 v[208:211], v5 offset:8192
    v_mfma_f32_16x16x32_bf16 v[56:59], v[152:155], v[220:223], v[56:59]
    v_mfma_f32_16x16x32_bf16 v[60:63], v[156:159], v[212:215], v[60:63]
    ds_read_b128 v[212:215], v5 offset:12288
    v_mfma_f32_16x16x32_bf16 v[64:67], v[156:159], v[216:219], v[64:67]
    ds_read_b128 v[216:219], v5 offset:13312
    v_mfma_f32_16x16x32_bf16 v[68:71], v[156:159], v[220:223], v[68:71]
    v_mfma_f32_16x16x32_bf16 v[96:99], v[188:191], v[240:243], v[96:99]
    ds_read_b128 v[220:223], v5 offset:14336
    v_mfma_f32_16x16x32_bf16 v[100:103], v[192:195], v[240:243], v[100:103]
    v_mfma_f32_16x16x32_bf16 v[104:107], v[196:199], v[240:243], v[104:107]
    v_mfma_f32_16x16x32_bf16 v[108:111], v[188:191], v[244:247], v[108:111]
    s_nop 3
    v_cvt_pk_bf16_f32 v144, v96, v97
    v_cvt_pk_bf16_f32 v145, v98, v99
    v_mfma_f32_16x16x32_bf16 v[112:115], v[192:195], v[244:247], v[112:115]
    v_cvt_pk_bf16_f32 v146, v100, v101
    v_cvt_pk_bf16_f32 v147, v102, v103
    v_mfma_f32_16x16x32_bf16 v[116:119], v[196:199], v[244:247], v[116:119]
    v_cvt_pk_bf16_f32 v162, v104, v105
    v_cvt_pk_bf16_f32 v163, v106, v107
    v_mfma_f32_16x16x32_bf16 v[120:123], v[188:191], v[248:251], v[120:123]
    v_cvt_pk_bf16_f32 v148, v108, v109
    v_cvt_pk_bf16_f32 v149, v110, v111
    v_mfma_f32_16x16x32_bf16 v[124:127], v[192:195], v[248:251], v[124:127]
    v_cvt_pk_bf16_f32 v150, v112, v113
    v_cvt_pk_bf16_f32 v151, v114, v115
    v_mfma_f32_16x16x32_bf16 v[128:131], v[196:199], v[248:251], v[128:131]
    v_cvt_pk_bf16_f32 v166, v116, v117
    v_cvt_pk_bf16_f32 v167, v118, v119
    v_mfma_f32_16x16x32_bf16 v[132:135], v[188:191], v[252:255], v[132:135]
    v_cvt_pk_bf16_f32 v152, v120, v121
    v_cvt_pk_bf16_f32 v153, v122, v123
    v_mfma_f32_16x16x32_bf16 v[136:139], v[192:195], v[252:255], v[136:139]
    v_cvt_pk_bf16_f32 v154, v124, v125
    v_cvt_pk_bf16_f32 v155, v126, v127
    v_mfma_f32_16x16x32_bf16 v[140:143], v[196:199], v[252:255], v[140:143]
    v_cvt_pk_bf16_f32 v170, v128, v129
    v_cvt_pk_bf16_f32 v171, v130, v131
    s_waitcnt lgkmcnt(0)
    v_mfma_f32_16x16x32_bf16 v[24:27], v[144:147], v[200:203], v[24:27]
    v_cvt_pk_bf16_f32 v156, v132, v133
    v_cvt_pk_bf16_f32 v157, v134, v135
    v_mfma_f32_16x16x32_bf16 v[28:31], v[144:147], v[204:207], v[28:31]
    v_cvt_pk_bf16_f32 v158, v136, v137
    v_cvt_pk_bf16_f32 v159, v138, v139
    v_mfma_f32_16x16x32_bf16 v[32:35], v[144:147], v[208:211], v[32:35]
    v_cvt_pk_bf16_f32 v174, v140, v141
    v_cvt_pk_bf16_f32 v175, v142, v143
    v_mfma_f32_16x16x32_bf16 v[36:39], v[148:151], v[200:203], v[36:39]
    v_mfma_f32_16x16x32_bf16 v[40:43], v[148:151], v[204:207], v[40:43]
    v_mfma_f32_16x16x32_bf16 v[44:47], v[148:151], v[208:211], v[44:47]
    v_mfma_f32_16x16x32_bf16 v[24:27], v[160:163], v[212:215], v[24:27]
    v_mfma_f32_16x16x32_bf16 v[28:31], v[160:163], v[216:219], v[28:31]
    v_mfma_f32_16x16x32_bf16 v[32:35], v[160:163], v[220:223], v[32:35]
    v_mfma_f32_16x16x32_bf16 v[36:39], v[164:167], v[212:215], v[36:39]
    s_nop 4
    v_cvt_pk_bf16_f32 v24, v24, v25
    v_cvt_pk_bf16_f32 v25, v26, v27
    v_mfma_f32_16x16x32_bf16 v[40:43], v[164:167], v[216:219], v[40:43]
    v_cvt_pk_bf16_f32 v28, v28, v29
    v_cvt_pk_bf16_f32 v29, v30, v31
    v_mfma_f32_16x16x32_bf16 v[44:47], v[164:167], v[220:223], v[44:47]
    v_cvt_pk_bf16_f32 v32, v32, v33
    v_cvt_pk_bf16_f32 v33, v34, v35
    v_mfma_f32_16x16x32_bf16 v[48:51], v[152:155], v[200:203], v[48:51]
    v_cvt_pk_bf16_f32 v26, v36, v37
    v_cvt_pk_bf16_f32 v27, v38, v39
    v_mfma_f32_16x16x32_bf16 v[52:55], v[152:155], v[204:207], v[52:55]
    buffer_store_dwordx4 v[24:27], v6, s[40:43], s100 offen offset:0 sc1
    v_cvt_pk_bf16_f32 v30, v40, v41
    v_mfma_f32_16x16x32_bf16 v[56:59], v[152:155], v[208:211], v[56:59]
    v_cvt_pk_bf16_f32 v31, v42, v43
    v_cvt_pk_bf16_f32 v34, v44, v45
    v_mfma_f32_16x16x32_bf16 v[60:63], v[156:159], v[200:203], v[60:63]
    v_cvt_pk_bf16_f32 v35, v46, v47
    buffer_store_dwordx4 v[28:31], v6, s[40:43], s100 offen offset:1024 sc1
    v_mfma_f32_16x16x32_bf16 v[64:67], v[156:159], v[204:207], v[64:67]
    buffer_store_dwordx4 v[32:35], v6, s[40:43], s100 offen offset:2048 sc1
    v_mfma_f32_16x16x32_bf16 v[68:71], v[156:159], v[208:211], v[68:71]
    v_mfma_f32_16x16x32_bf16 v[48:51], v[168:171], v[212:215], v[48:51]
    v_mfma_f32_16x16x32_bf16 v[52:55], v[168:171], v[216:219], v[52:55]
    v_mfma_f32_16x16x32_bf16 v[56:59], v[168:171], v[220:223], v[56:59]
    v_mfma_f32_16x16x32_bf16 v[60:63], v[172:175], v[212:215], v[60:63]
    s_nop 4
    v_cvt_pk_bf16_f32 v48, v48, v49
    v_cvt_pk_bf16_f32 v49, v50, v51
    v_mfma_f32_16x16x32_bf16 v[64:67], v[172:175], v[216:219], v[64:67]
    v_cvt_pk_bf16_f32 v52, v52, v53
    v_cvt_pk_bf16_f32 v53, v54, v55
    v_mfma_f32_16x16x32_bf16 v[68:71], v[172:175], v[220:223], v[68:71]
    v_cvt_pk_bf16_f32 v56, v56, v57
    v_cvt_pk_bf16_f32 v57, v58, v59
    v_cvt_pk_bf16_f32 v50, v60, v61
    v_cvt_pk_bf16_f32 v51, v62, v63
    buffer_store_dwordx4 v[48:51], v6, s[40:43], s101 offen offset:0 sc1
    v_cvt_pk_bf16_f32 v54, v64, v65
    v_cvt_pk_bf16_f32 v55, v66, v67
    buffer_store_dwordx4 v[52:55], v6, s[40:43], s101 offen offset:1024 sc1
    v_cvt_pk_bf16_f32 v58, v68, v69
    v_cvt_pk_bf16_f32 v59, v70, v71
    buffer_store_dwordx4 v[56:59], v6, s[40:43], s101 offen offset:2048 sc1
    s_cmp_eq_u32 s58, s53
    s_cbranch_scc1 L_own
    s_barrier
    s_waitcnt vmcnt(0)
    buffer_store_dwordx2 v[84:85], v7, s[40:43], s12 offen sc1
    s_branch L_ownd
L_own:
    ds_write_b128 v6, v[24:27] offset:0
    ds_write_b128 v6, v[28:31] offset:1024
    ds_write_b128 v6, v[32:35] offset:2048
    ds_write_b128 v6, v[48:51] offset:3072
    ds_write_b128 v6, v[52:55] offset:4096
    ds_write_b128 v6, v[56:59] offset:5120
    s_waitcnt lgkmcnt(0)
    s_barrier
L_ownd:
    v_add_u32 v120, s9, v6
    ds_read_b128 v[108:111], v120 offset:0
    s_waitcnt lgkmcnt(0)
    v_lshlrev_b32 v112, 16, v108
    v_and_b32 v113, 0xffff0000, v108
    v_lshlrev_b32 v114, 16, v109
    v_and_b32 v115, 0xffff0000, v109
    v_lshlrev_b32 v116, 16, v110
    v_and_b32 v117, 0xffff0000, v110
    v_lshlrev_b32 v118, 16, v111
    v_and_b32 v119, 0xffff0000, v111
    s_mov_b32 s69, 500000
L_gc:
    buffer_load_dwordx2 v[124:125], v1, s[40:43], s11 offen sc1
    s_sub_u32 s69, s69, 1
    s_waitcnt vmcnt(0)
    v_cmp_ne_u64 vcc, s[66:67], v[124:125]
    s_cbranch_vccz L_gcd
    s_cmp_lg_u32 s69, 0
    s_cbranch_scc1 L_gc
L_gcd:
    buffer_load_dwordx4 v[96:99], v6, s[40:43], s6 offen sc1
    buffer_load_dwordx4 v[100:103], v6, s[40:43], s7 offen sc1
    buffer_load_dwordx4 v[104:107], v6, s[40:43], s8 offen sc1
    s_waitcnt vmcnt(2)
    v_lshlrev_b32 v120, 16, v96
    v_and_b32 v121, 0xffff0000, v96
    v_pk_add_f32 v[112:113], v[112:113], v[120:121]
    v_lshlrev_b32 v122, 16, v97
    v_and_b32 v123, 0xffff0000, v97
    v_pk_add_f32 v[114:115], v[114:115], v[122:123]
    v_lshlrev_b32 v120, 16, v98
    v_and_b32 v121, 0xffff0000, v98
    v_pk_add_f32 v[116:117], v[116:117], v[120:121]
    v_lshlrev_b32 v122, 16, v99
    v_and_b32 v123, 0xffff0000, v99
    v_pk_add_f32 v[118:119], v[118:119], v[122:123]
    s_waitcnt vmcnt(1)
    v_lshlrev_b32 v120, 16, v100
    v_and_b32 v121, 0xffff0000, v100
    v_pk_add_f32 v[112:113], v[112:113], v[120:121]
    v_lshlrev_b32 v122, 16, v101
    v_and_b32 v123, 0xffff0000, v101
    v_pk_add_f32 v[114:115], v[114:115], v[122:123]
    v_lshlrev_b32 v120, 16, v102
    v_and_b32 v121, 0xffff0000, v102
    v_pk_add_f32 v[116:117], v[116:117], v[120:121]
    v_lshlrev_b32 v122, 16, v103
    v_and_b32 v123, 0xffff0000, v103
    v_pk_add_f32 v[118:119], v[118:119], v[122:123]
    s_waitcnt vmcnt(0)
    v_lshlrev_b32 v120, 16, v104
    v_and_b32 v121, 0xffff0000, v104
    v_pk_add_f32 v[112:113], v[112:113], v[120:121]
    v_lshlrev_b32 v122, 16, v105
    v_and_b32 v123, 0xffff0000, v105
    v_pk_add_f32 v[114:115], v[114:115], v[122:123]
    v_lshlrev_b32 v120, 16, v106
    v_and_b32 v121, 0xffff0000, v106
    v_pk_add_f32 v[116:117], v[116:117], v[120:121]
    v_lshlrev_b32 v122, 16, v107
    v_and_b32 v123, 0xffff0000, v107
    v_pk_add_f32 v[118:119], v[118:119], v[122:123]
    v_cvt_pk_bf16_f32 v96, v112, v113
    v_cvt_pk_bf16_f32 v97, v114, v115
    v_cvt_pk_bf16_f32 v98, v116, v117
    v_cvt_pk_bf16_f32 v99, v118, v119
    s_nop 0
    v_permlane16_swap_b32 v96, v98
    v_permlane16_swap_b32 v97, v99
    buffer_store_dwordx4 v[96:99], v2, s[44:47], s10 offen
    s_endpgm
Wc_end:
L_end:
    s_endpgm
.section .rodata,"a"
.p2align 6
.amdhsa_kernel concat_heads__gqa_block_cached__gqa_block_cached__near_ridge_kernel
  .amdhsa_next_free_vgpr 256
  .amdhsa_next_free_sgpr 102
  .amdhsa_accum_offset 256
  .amdhsa_group_segment_fixed_size 0
  .amdhsa_kernarg_size 104
  .amdhsa_user_sgpr_count 2
  .amdhsa_user_sgpr_kernarg_segment_ptr 1
  .amdhsa_system_sgpr_workgroup_id_x 1
.end_amdhsa_kernel
```
